```python
import torch

def _softmax(x, axis=-1):
    return torch.softmax(x, dim=axis)
def _gelu(x):
    return torch.nn.functional.gelu(x, approximate="tanh")
def _silu(x):
    return torch.nn.functional.silu(x)
def _sigmoid(x):
    return torch.sigmoid(x)
def _layernorm(x, axis=-1, eps=1e-5):
    m = x.mean(dim=axis, keepdim=True)
    v = x.var(dim=axis, keepdim=True, unbiased=False)
    return (x - m) / torch.sqrt(v + eps)
def _scatter_add(tgt, idx, src, axis=0):
    return tgt.clone().index_add_(axis, idx, src)
def _segment_sum(src, seg, n):
    out = torch.zeros((n,) + src.shape[1:], dtype=src.dtype)
    return out.index_add_(0, seg, src)
def _pad(x, pw):
    flat = tuple(v for pair in reversed(pw) for v in pair)
    return torch.nn.functional.pad(x, flat)

kernel_name = 'gated_mix__sliding_block_cached__dense_activation_squared_relu__decode'

def setup_inputs():

    _w = (lambda a: (lambda t: t.to(torch.bfloat16) if t.is_floating_point() else t)(torch.as_tensor(a)))
    def _A_setup():
        B, Sq, D = 1, 1, 448
        Hq, Hkv, Sk, Dh = 16, 8, 65536, 256
        assert Hq % Hkv == 0, (Hq, Hkv)
        return {
            "x": _w((lambda *s: torch.randn(*s, dtype=torch.bfloat16) * 0.05)(B, Sq, D)),
            "k_cache": _w((lambda *s: torch.randn(*s, dtype=torch.bfloat16) * 3.2)(B, Hkv, Sk, Dh)),
            "v_cache": _w((lambda *s: torch.randn(*s, dtype=torch.bfloat16) * 1.6)(B, Hkv, Sk, Dh)),
            "wq": _w((lambda *s: torch.randn(*s, dtype=torch.bfloat16) * 3.2)(D, Hq * Dh) * (D ** -0.5)),
            "wo": _w((lambda *s: torch.randn(*s, dtype=torch.bfloat16) * 1.6)(Hq * Dh, D) * ((Hq * Dh) ** -0.5)),
        }
    _A_in = _A_setup()

    def _B_setup():
        B, S, D, F = 1, 1, 448, 1792
        return {
            "x": _w((lambda *s: torch.randn(*s, dtype=torch.bfloat16) * 0.05)(B, S, D)),
            "w1": _w((lambda *s: torch.randn(*s, dtype=torch.bfloat16) * 0.1)(D, F)),
            "b1": _w((lambda *s: torch.randn(*s, dtype=torch.bfloat16) * 0.05)(F)),
            "w2": _w((lambda *s: torch.randn(*s, dtype=torch.bfloat16) * 0.05)(F, D)),
            "b2": _w((lambda *s: torch.randn(*s, dtype=torch.bfloat16) * 0.05)(D)),
        }
    _B_in = _B_setup()

    return {
        "A_x": _A_in["x"],
        "A_k_cache": _A_in["k_cache"],
        "A_v_cache": _A_in["v_cache"],
        "A_wq": _A_in["wq"],
        "A_wo": _A_in["wo"],
        "B_x": _B_in["x"],
        "B_w1": _B_in["w1"],
        "B_b1": _B_in["b1"],
        "B_w2": _B_in["w2"],
        "B_b2": _B_in["b2"],
        "gate_w": _w((lambda *s: torch.randn(*s, dtype=torch.bfloat16) * 0.05)(448) * 16.0),
    }

def reference(A_x, A_k_cache, A_v_cache, A_wq, A_wo, B_x, B_w1, B_b1, B_w2, B_b2, gate_w):
    def _A_ref(x, k_cache, v_cache, wq, wo):
        B, Sq, D = x.shape
        Hq, Dh = 16, 256
        Hkv, Sk = k_cache.shape[1], k_cache.shape[2]
        W = min(4096, max(256, Sk // 4))
        rep = Hq // Hkv
        q = (lambda x, *d: x.permute(*d))((x @ wq).reshape(B, Sq, Hq, Dh), 0, 2, 1, 3)
        k = (lambda x, n, axis: torch.repeat_interleave(x, n, dim=axis))(k_cache[:, :, Sk - W:, :], rep, axis=1)
        v = (lambda x, n, axis: torch.repeat_interleave(x, n, dim=axis))(v_cache[:, :, Sk - W:, :], rep, axis=1)
        scores = torch.einsum("bhqd,bhkd->bhqk", q, k) * (Dh ** -0.5)
        p = _softmax(scores, axis=-1)
        o = torch.einsum("bhqk,bhkd->bhqd", p, v)
        return (lambda x, *d: x.permute(*d))(o, 0, 2, 1, 3).reshape(B, Sq, Hq * Dh) @ wo

    def _B_ref(x, w1, b1, w2, b2):
        h = torch.einsum("bsd,df->bsf", x, w1) + b1
        zero = torch.zeros_like(h)
        r = torch.where(h > zero, h, zero)
        h = r * r
        out = torch.einsum("bsf,fd->bsd", h, w2) + b2
        return out

    x = A_x
    g = _sigmoid((x * gate_w).sum(-1, keepdims=True))
    a = _A_ref(x, A_k_cache, A_v_cache, A_wq, A_wo)
    b = _B_ref(x, B_w1, B_b1, B_w2, B_b2)
    return g * a + (1 - g) * b
```

```asm
; @launch grid=(256,1,1) block=(512,1,1) lds=149504
.amdgcn_target "amdgcn-amd-amdhsa--gfx950"
.text
.globl gated_mix__sliding_block_cached__dense_activation_squared_relu__decode_kernel
.p2align 8
.type gated_mix__sliding_block_cached__dense_activation_squared_relu__decode_kernel,@function
gated_mix__sliding_block_cached__dense_activation_squared_relu__decode_kernel:
    s_cmp_ge_u32 s2, 256
    s_cbranch_scc1 L_END
    s_load_dwordx16 s[16:31], s[0:1], 0
    s_load_dwordx8 s[32:39], s[0:1], 64
    s_load_dwordx4 s[40:43], s[0:1], 96
    v_lshrrev_b32 v2, 6, v0
    v_and_b32 v1, 63, v0
    s_and_b32 s4, s2, 7
    v_readfirstlane_b32 s3, v2
    s_lshr_b32 s5, s2, 3
    s_lshr_b32 s6, s5, 4
    s_and_b32 s7, s5, 3
    s_lshr_b32 s8, s5, 2
    s_lshl_b32 s8, s8, 3
    s_add_u32 s8, s8, s4
    s_cmp_lt_u32 s8, 28
    s_cselect_b32 s9, 1, 0
    s_cselect_b32 s8, s8, 0
    s_cmp_lt_u32 s3, 4
    s_cbranch_scc1 L_CONS
    s_sub_u32 s82, s3, 4
    v_lshrrev_b32 v6, 3, v1
    v_bfe_u32 v7, v6, 1, 2
    v_lshlrev_b32 v7, 1, v7
    v_and_b32 v11, 7, v1
    v_xor_b32 v11, v11, v7
    v_lshlrev_b32 v11, 4, v11
    s_lshl_b32 s10, s82, 3
    v_add_u32 v6, s10, v6
    v_lshl_add_u32 v7, v6, 13, v11
    v_mul_u32_u24 v10, 3584, v6
    v_add_u32 v10, v10, v11
    v_lshrrev_b32 v13, 5, v1
    v_lshlrev_b32 v8, 9, v13
    v_and_b32 v9, 31, v1
    v_lshl_add_u32 v8, v9, 4, v8
    s_lshl_b32 s10, s82, 1
    v_add_u32 v13, s10, v13
    v_lshlrev_b32 v13, 5, v13
    v_xor_b32 v9, v8, v13
    s_lshl_b32 s10, s82, 4
    v_xor_b32 v8, s10, v8
    v_lshlrev_b32 v11, 4, v1
    s_lshl_b32 s10, s82, 2
    s_add_u32 s10, s10, 147968
    v_add_u32 v12, s10, v11
    v_mov_b32 v5, 148992
    s_lshl_b32 s83, s82, 10
    s_add_u32 s84, s83, 65536
    s_add_u32 s85, s83, 131072
    s_mul_i32 s86, s82, 3712
    s_mul_i32 s87, s82, 3584
    s_cmp_ge_u32 s82, 2
    s_cselect_b32 s88, 2, 3
    s_mul_i32 s89, s2, 7
    s_add_u32 s89, s89, s82
    s_lshl_b32 s89, s89, 10
    s_mul_i32 s12, s7, 917504
    s_lshl_b32 s11, s4, 10
    s_add_u32 s12, s12, s11
    s_lshr_b32 s11, s5, 2
    s_lshl_b32 s11, s11, 7
    s_add_u32 s12, s12, s11
    s_sub_u32 s11, 3670016, s12
    s_lshl_b32 s13, s4, 25
    s_add_u32 s13, s13, 0x1E00000
    s_lshl_b32 s10, s5, 16
    s_add_u32 s13, s13, s10
    s_waitcnt lgkmcnt(0)
    s_add_u32 s64, s22, s12
    s_addc_u32 s65, s23, 0
    s_mov_b32 s66, s11
    s_mov_b32 s67, 0x00020000
    s_add_u32 m0, s85, 0
    s_mov_b32 s10, 0
    buffer_load_dwordx4 v7, s[64:67], s10 offen nt lds
    s_add_u32 m0, s85, 4096
    s_mov_b32 s10, 262144
    buffer_load_dwordx4 v7, s[64:67], s10 offen nt lds
    s_add_u32 m0, s85, 8192
    s_mov_b32 s10, 524288
    buffer_load_dwordx4 v7, s[64:67], s10 offen nt lds
    s_mov_b32 s68, s16
    s_mov_b32 s69, s17
    s_mov_b32 s70, 896
    s_mov_b32 s71, 0x00020000
    s_cmp_eq_u32 s82, 3
    s_cbranch_scc1 L_LX
    s_lshl_b32 s10, s88, 12
    s_add_u32 m0, s85, s10
    s_mul_i32 s10, s88, 262144
    buffer_load_dwordx4 v7, s[64:67], s10 offen nt lds
    s_branch L_LX2
L_LX:
    s_mov_b32 m0, 145408
    s_nop 0
    buffer_load_dwordx4 v11, s[68:71], 0 offen lds
L_LX2:
    s_add_u32 s44, s18, s13
    s_addc_u32 s45, s19, 0
    s_mov_b32 s46, 65536
    s_mov_b32 s47, 0x00020000
    v_xor_b32 v13, 0, v8
    s_add_u32 m0, s83, 0
    s_add_u32 s10, s89, 0
    s_and_b32 s10, s10, 0xffff
    buffer_load_dwordx4 v13, s[44:47], s10 offen nt lds
    s_add_u32 s48, s20, s13
    s_addc_u32 s49, s21, 0
    s_mov_b32 s50, 65536
    s_mov_b32 s51, 0x00020000
    s_mul_i32 s11, s7, 401408
    s_lshl_b32 s12, s8, 7
    s_add_u32 s11, s11, s12
    s_sub_u32 s12, 1605632, s11
    s_add_u32 s52, s28, s11
    s_addc_u32 s53, s29, 0
    s_mov_b32 s54, s12
    s_mov_b32 s55, 0x00020000
    s_lshl_b32 s11, s4, 9
    s_lshl_b32 s12, s5, 4
    s_add_u32 s11, s11, s12
    s_mul_i32 s11, s11, 896
    s_add_u32 s56, s24, s11
    s_addc_u32 s57, s25, 0
    s_mov_b32 s58, 14336
    s_mov_b32 s59, 0x00020000
    s_lshl_b32 s11, s8, 2
    s_add_u32 s11, s11, s7
    s_mul_i32 s11, s11, 14336
    s_add_u32 s60, s32, s11
    s_addc_u32 s61, s33, 0
    s_mov_b32 s62, 14336
    s_mov_b32 s63, 0x00020000
    s_mov_b32 s72, s42
    s_mov_b32 s73, s43
    s_mov_b32 s74, 0x1000000
    s_mov_b32 s75, 0x00020000
    s_barrier
    s_cmp_eq_u32 s9, 0
    s_cbranch_scc1 L_LOADER_N
    v_xor_b32 v13, 64, v8
    s_add_u32 m0, s83, 4096
    s_add_u32 s10, s89, 4096
    s_and_b32 s10, s10, 0xffff
    buffer_load_dwordx4 v13, s[44:47], s10 offen nt lds
    s_waitcnt vmcnt(5)
    v_xor_b32 v13, 128, v8
    s_add_u32 m0, s83, 8192
    s_add_u32 s10, s89, 8192
    s_and_b32 s10, s10, 0xffff
    buffer_load_dwordx4 v13, s[44:47], s10 offen nt lds
    s_waitcnt vmcnt(5)
    v_xor_b32 v13, 192, v8
    s_add_u32 m0, s83, 12288
    s_add_u32 s10, s89, 12288
    s_and_b32 s10, s10, 0xffff
    buffer_load_dwordx4 v13, s[44:47], s10 offen nt lds
    s_waitcnt vmcnt(5)
    v_xor_b32 v13, 0, v8
    s_add_u32 m0, s83, 16384
    s_add_u32 s10, s89, 16384
    s_and_b32 s10, s10, 0xffff
    buffer_load_dwordx4 v13, s[44:47], s10 offen nt lds
    s_waitcnt vmcnt(5)
    v_mov_b32 v14, 1
    ds_write_b32 v12, v14
    v_xor_b32 v13, 64, v8
    s_add_u32 m0, s83, 20480
    s_add_u32 s10, s89, 20480
    s_and_b32 s10, s10, 0xffff
    buffer_load_dwordx4 v13, s[44:47], s10 offen nt lds
    s_waitcnt vmcnt(5)
    v_xor_b32 v13, 128, v8
    s_add_u32 m0, s83, 24576
    s_add_u32 s10, s89, 24576
    s_and_b32 s10, s10, 0xffff
    buffer_load_dwordx4 v13, s[44:47], s10 offen nt lds
    s_waitcnt vmcnt(5)
    v_xor_b32 v13, 192, v8
    s_add_u32 m0, s83, 28672
    s_add_u32 s10, s89, 28672
    s_and_b32 s10, s10, 0xffff
    buffer_load_dwordx4 v13, s[44:47], s10 offen nt lds
    s_waitcnt vmcnt(5)
    v_xor_b32 v13, 0, v8
    s_add_u32 m0, s83, 32768
    s_add_u32 s10, s89, 32768
    s_and_b32 s10, s10, 0xffff
    buffer_load_dwordx4 v13, s[44:47], s10 offen nt lds
    s_waitcnt vmcnt(5)
    v_mov_b32 v14, 2
    ds_write_b32 v12, v14
    v_xor_b32 v13, 64, v8
    s_add_u32 m0, s83, 36864
    s_add_u32 s10, s89, 36864
    s_and_b32 s10, s10, 0xffff
    buffer_load_dwordx4 v13, s[44:47], s10 offen nt lds
    s_waitcnt vmcnt(5)
    v_xor_b32 v13, 128, v8
    s_add_u32 m0, s83, 40960
    s_add_u32 s10, s89, 40960
    s_and_b32 s10, s10, 0xffff
    buffer_load_dwordx4 v13, s[44:47], s10 offen nt lds
    s_waitcnt vmcnt(5)
    v_xor_b32 v13, 192, v8
    s_add_u32 m0, s83, 45056
    s_add_u32 s10, s89, 45056
    s_and_b32 s10, s10, 0xffff
    buffer_load_dwordx4 v13, s[44:47], s10 offen nt lds
    s_waitcnt vmcnt(5)
    v_xor_b32 v13, 0, v8
    s_add_u32 m0, s83, 49152
    s_add_u32 s10, s89, 49152
    s_and_b32 s10, s10, 0xffff
    buffer_load_dwordx4 v13, s[44:47], s10 offen nt lds
    s_waitcnt vmcnt(5)
    v_mov_b32 v14, 3
    ds_write_b32 v12, v14
    v_xor_b32 v13, 64, v8
    s_add_u32 m0, s83, 53248
    s_add_u32 s10, s89, 53248
    s_and_b32 s10, s10, 0xffff
    buffer_load_dwordx4 v13, s[44:47], s10 offen nt lds
    s_waitcnt vmcnt(5)
    v_xor_b32 v13, 128, v8
    s_add_u32 m0, s83, 57344
    s_add_u32 s10, s89, 57344
    s_and_b32 s10, s10, 0xffff
    buffer_load_dwordx4 v13, s[44:47], s10 offen nt lds
    s_waitcnt vmcnt(5)
    v_xor_b32 v13, 192, v8
    s_add_u32 m0, s83, 61440
    s_add_u32 s10, s89, 61440
    s_and_b32 s10, s10, 0xffff
    buffer_load_dwordx4 v13, s[44:47], s10 offen nt lds
    s_waitcnt vmcnt(5)
SP_1:
    ds_read_b32 v15, v5 offset:276
    s_waitcnt lgkmcnt(0)
    v_readfirstlane_b32 s10, v15
    s_cmp_ge_u32 s10, 4
    s_cbranch_scc1 SD_2
    s_sleep 1
    s_branch SP_1
SD_2:
    s_add_u32 m0, s85, 0
    s_mov_b32 s10, 0
    buffer_load_dwordx4 v10, s[52:55], s10 offen nt lds
    s_waitcnt vmcnt(5)
    v_mov_b32 v14, 4
    ds_write_b32 v12, v14
    s_add_u32 m0, s85, 4096
    s_mov_b32 s10, 114688
    buffer_load_dwordx4 v10, s[52:55], s10 offen nt lds
    s_waitcnt vmcnt(5)
    s_add_u32 m0, s85, 8192
    s_mov_b32 s10, 229376
    buffer_load_dwordx4 v10, s[52:55], s10 offen nt lds
    s_waitcnt vmcnt(5)
    s_lshl_b32 s10, s88, 12
    s_add_u32 m0, s85, s10
    s_mul_i32 s10, s88, 114688
    buffer_load_dwordx4 v10, s[52:55], s10 offen nt lds
    s_waitcnt vmcnt(5)
    s_add_u32 m0, s84, 0
    s_add_u32 s10, s89, 0
    s_and_b32 s10, s10, 0xffff
    buffer_load_dwordx4 v9, s[48:51], s10 offen nt lds
    s_waitcnt vmcnt(5)
    v_mov_b32 v14, 5
    ds_write_b32 v12, v14
    s_add_u32 m0, s84, 4096
    s_add_u32 s10, s89, 4096
    s_and_b32 s10, s10, 0xffff
    buffer_load_dwordx4 v9, s[48:51], s10 offen nt lds
    s_waitcnt vmcnt(5)
    s_add_u32 m0, s84, 8192
    s_add_u32 s10, s89, 8192
    s_and_b32 s10, s10, 0xffff
    buffer_load_dwordx4 v9, s[48:51], s10 offen nt lds
    s_waitcnt vmcnt(5)
    s_add_u32 m0, s84, 12288
    s_add_u32 s10, s89, 12288
    s_and_b32 s10, s10, 0xffff
    buffer_load_dwordx4 v9, s[48:51], s10 offen nt lds
    s_waitcnt vmcnt(5)
    s_add_u32 m0, s84, 16384
    s_add_u32 s10, s89, 16384
    s_and_b32 s10, s10, 0xffff
    buffer_load_dwordx4 v9, s[48:51], s10 offen nt lds
    s_waitcnt vmcnt(5)
    v_mov_b32 v14, 6
    ds_write_b32 v12, v14
    s_add_u32 m0, s84, 20480
    s_add_u32 s10, s89, 20480
    s_and_b32 s10, s10, 0xffff
    buffer_load_dwordx4 v9, s[48:51], s10 offen nt lds
    s_waitcnt vmcnt(5)
    s_add_u32 m0, s84, 24576
    s_add_u32 s10, s89, 24576
    s_and_b32 s10, s10, 0xffff
    buffer_load_dwordx4 v9, s[48:51], s10 offen nt lds
    s_waitcnt vmcnt(5)
    s_add_u32 m0, s84, 28672
    s_add_u32 s10, s89, 28672
    s_and_b32 s10, s10, 0xffff
    buffer_load_dwordx4 v9, s[48:51], s10 offen nt lds
    s_waitcnt vmcnt(5)
    s_add_u32 m0, s84, 32768
    s_add_u32 s10, s89, 32768
    s_and_b32 s10, s10, 0xffff
    buffer_load_dwordx4 v9, s[48:51], s10 offen nt lds
    s_waitcnt vmcnt(5)
    v_mov_b32 v14, 7
    ds_write_b32 v12, v14
    s_add_u32 m0, s84, 36864
    s_add_u32 s10, s89, 36864
    s_and_b32 s10, s10, 0xffff
    buffer_load_dwordx4 v9, s[48:51], s10 offen nt lds
    s_waitcnt vmcnt(5)
    s_add_u32 m0, s84, 40960
    s_add_u32 s10, s89, 40960
    s_and_b32 s10, s10, 0xffff
    buffer_load_dwordx4 v9, s[48:51], s10 offen nt lds
    s_waitcnt vmcnt(5)
    s_add_u32 m0, s84, 45056
    s_add_u32 s10, s89, 45056
    s_and_b32 s10, s10, 0xffff
    buffer_load_dwordx4 v9, s[48:51], s10 offen nt lds
    s_waitcnt vmcnt(5)
    s_add_u32 m0, s84, 49152
    s_add_u32 s10, s89, 49152
    s_and_b32 s10, s10, 0xffff
    buffer_load_dwordx4 v9, s[48:51], s10 offen nt lds
    s_waitcnt vmcnt(5)
    v_mov_b32 v14, 8
    ds_write_b32 v12, v14
    s_add_u32 m0, s84, 53248
    s_add_u32 s10, s89, 53248
    s_and_b32 s10, s10, 0xffff
    buffer_load_dwordx4 v9, s[48:51], s10 offen nt lds
    s_waitcnt vmcnt(5)
    s_add_u32 m0, s84, 57344
    s_add_u32 s10, s89, 57344
    s_and_b32 s10, s10, 0xffff
    buffer_load_dwordx4 v9, s[48:51], s10 offen nt lds
    s_waitcnt vmcnt(5)
    s_add_u32 m0, s84, 61440
    s_add_u32 s10, s89, 61440
    s_and_b32 s10, s10, 0xffff
    buffer_load_dwordx4 v9, s[48:51], s10 offen nt lds
    s_waitcnt vmcnt(5)
SP_3:
    ds_read_b32 v15, v5 offset:264
    s_waitcnt lgkmcnt(0)
    v_readfirstlane_b32 s10, v15
    s_cmp_ge_u32 s10, 4
    s_cbranch_scc1 SD_4
    s_sleep 1
    s_branch SP_3
SD_4:
    s_mov_b32 exec_hi, 0x00ffffff
    s_add_u32 m0, s86, 0
    s_add_u32 s10, s87, 0
    buffer_load_dwordx4 v11, s[56:59], s10 offen nt lds
    s_waitcnt vmcnt(5)
    v_mov_b32 v14, 9
    ds_write_b32 v12, v14
    s_add_u32 m0, s86, 928
    s_add_u32 s10, s87, 896
    buffer_load_dwordx4 v11, s[56:59], s10 offen nt lds
    s_waitcnt vmcnt(5)
    s_add_u32 m0, s86, 1856
    s_add_u32 s10, s87, 1792
    buffer_load_dwordx4 v11, s[56:59], s10 offen nt lds
    s_waitcnt vmcnt(5)
    s_add_u32 m0, s86, 2784
    s_add_u32 s10, s87, 2688
    buffer_load_dwordx4 v11, s[56:59], s10 offen nt lds
    s_waitcnt vmcnt(5)
    s_add_u32 m0, s86, 14848
    s_add_u32 s10, s87, 0
    buffer_load_dwordx4 v11, s[60:63], s10 offen nt lds
    s_waitcnt vmcnt(5)
    v_mov_b32 v14, 10
    ds_write_b32 v12, v14
    s_add_u32 m0, s86, 15776
    s_add_u32 s10, s87, 896
    buffer_load_dwordx4 v11, s[60:63], s10 offen nt lds
    s_waitcnt vmcnt(5)
    s_add_u32 m0, s86, 16704
    s_add_u32 s10, s87, 1792
    buffer_load_dwordx4 v11, s[60:63], s10 offen nt lds
    s_waitcnt vmcnt(5)
    s_add_u32 m0, s86, 17632
    s_add_u32 s10, s87, 2688
    buffer_load_dwordx4 v11, s[60:63], s10 offen nt lds
    s_waitcnt vmcnt(4)
    v_mov_b32 v14, 11
    ds_write_b32 v12, v14
    s_waitcnt vmcnt(0)
    v_mov_b32 v14, 12
    ds_write_b32 v12, v14
    s_endpgm
L_LOADER_N:
    s_waitcnt vmcnt(4)
    v_xor_b32 v13, 64, v8
    s_add_u32 m0, s83, 4096
    s_add_u32 s10, s89, 4096
    s_and_b32 s10, s10, 0xffff
    buffer_load_dwordx4 v13, s[44:47], s10 offen nt lds
    s_waitcnt vmcnt(4)
    v_xor_b32 v13, 128, v8
    s_add_u32 m0, s83, 8192
    s_add_u32 s10, s89, 8192
    s_and_b32 s10, s10, 0xffff
    buffer_load_dwordx4 v13, s[44:47], s10 offen nt lds
    s_waitcnt vmcnt(4)
    v_xor_b32 v13, 192, v8
    s_add_u32 m0, s83, 12288
    s_add_u32 s10, s89, 12288
    s_and_b32 s10, s10, 0xffff
    buffer_load_dwordx4 v13, s[44:47], s10 offen nt lds
    s_waitcnt vmcnt(4)
    v_mov_b32 v14, 1
    ds_write_b32 v12, v14
    v_xor_b32 v13, 0, v8
    s_add_u32 m0, s83, 16384
    s_add_u32 s10, s89, 16384
    s_and_b32 s10, s10, 0xffff
    buffer_load_dwordx4 v13, s[44:47], s10 offen nt lds
    s_waitcnt vmcnt(4)
    v_xor_b32 v13, 64, v8
    s_add_u32 m0, s83, 20480
    s_add_u32 s10, s89, 20480
    s_and_b32 s10, s10, 0xffff
    buffer_load_dwordx4 v13, s[44:47], s10 offen nt lds
    s_waitcnt vmcnt(4)
    v_xor_b32 v13, 128, v8
    s_add_u32 m0, s83, 24576
    s_add_u32 s10, s89, 24576
    s_and_b32 s10, s10, 0xffff
    buffer_load_dwordx4 v13, s[44:47], s10 offen nt lds
    s_waitcnt vmcnt(4)
    v_xor_b32 v13, 192, v8
    s_add_u32 m0, s83, 28672
    s_add_u32 s10, s89, 28672
    s_and_b32 s10, s10, 0xffff
    buffer_load_dwordx4 v13, s[44:47], s10 offen nt lds
    s_waitcnt vmcnt(4)
    v_mov_b32 v14, 2
    ds_write_b32 v12, v14
    v_xor_b32 v13, 0, v8
    s_add_u32 m0, s83, 32768
    s_add_u32 s10, s89, 32768
    s_and_b32 s10, s10, 0xffff
    buffer_load_dwordx4 v13, s[44:47], s10 offen nt lds
    s_waitcnt vmcnt(4)
    v_xor_b32 v13, 64, v8
    s_add_u32 m0, s83, 36864
    s_add_u32 s10, s89, 36864
    s_and_b32 s10, s10, 0xffff
    buffer_load_dwordx4 v13, s[44:47], s10 offen nt lds
    s_waitcnt vmcnt(4)
    v_xor_b32 v13, 128, v8
    s_add_u32 m0, s83, 40960
    s_add_u32 s10, s89, 40960
    s_and_b32 s10, s10, 0xffff
    buffer_load_dwordx4 v13, s[44:47], s10 offen nt lds
    s_waitcnt vmcnt(4)
    v_xor_b32 v13, 192, v8
    s_add_u32 m0, s83, 45056
    s_add_u32 s10, s89, 45056
    s_and_b32 s10, s10, 0xffff
    buffer_load_dwordx4 v13, s[44:47], s10 offen nt lds
    s_waitcnt vmcnt(4)
    v_mov_b32 v14, 3
    ds_write_b32 v12, v14
    v_xor_b32 v13, 0, v8
    s_add_u32 m0, s83, 49152
    s_add_u32 s10, s89, 49152
    s_and_b32 s10, s10, 0xffff
    buffer_load_dwordx4 v13, s[44:47], s10 offen nt lds
    s_waitcnt vmcnt(4)
    v_xor_b32 v13, 64, v8
    s_add_u32 m0, s83, 53248
    s_add_u32 s10, s89, 53248
    s_and_b32 s10, s10, 0xffff
    buffer_load_dwordx4 v13, s[44:47], s10 offen nt lds
    s_waitcnt vmcnt(4)
    v_xor_b32 v13, 128, v8
    s_add_u32 m0, s83, 57344
    s_add_u32 s10, s89, 57344
    s_and_b32 s10, s10, 0xffff
    buffer_load_dwordx4 v13, s[44:47], s10 offen nt lds
    s_waitcnt vmcnt(4)
    v_xor_b32 v13, 192, v8
    s_add_u32 m0, s83, 61440
    s_add_u32 s10, s89, 61440
    s_and_b32 s10, s10, 0xffff
    buffer_load_dwordx4 v13, s[44:47], s10 offen nt lds
    s_waitcnt vmcnt(4)
    v_mov_b32 v14, 4
    ds_write_b32 v12, v14
    s_add_u32 m0, s84, 0
    s_add_u32 s10, s89, 0
    s_and_b32 s10, s10, 0xffff
    buffer_load_dwordx4 v9, s[48:51], s10 offen nt lds
    s_waitcnt vmcnt(4)
    s_add_u32 m0, s84, 4096
    s_add_u32 s10, s89, 4096
    s_and_b32 s10, s10, 0xffff
    buffer_load_dwordx4 v9, s[48:51], s10 offen nt lds
    s_waitcnt vmcnt(4)
    s_add_u32 m0, s84, 8192
    s_add_u32 s10, s89, 8192
    s_and_b32 s10, s10, 0xffff
    buffer_load_dwordx4 v9, s[48:51], s10 offen nt lds
    s_waitcnt vmcnt(4)
    s_add_u32 m0, s84, 12288
    s_add_u32 s10, s89, 12288
    s_and_b32 s10, s10, 0xffff
    buffer_load_dwordx4 v9, s[48:51], s10 offen nt lds
    s_waitcnt vmcnt(4)
    v_mov_b32 v14, 5
    ds_write_b32 v12, v14
    s_add_u32 m0, s84, 16384
    s_add_u32 s10, s89, 16384
    s_and_b32 s10, s10, 0xffff
    buffer_load_dwordx4 v9, s[48:51], s10 offen nt lds
    s_waitcnt vmcnt(4)
    s_add_u32 m0, s84, 20480
    s_add_u32 s10, s89, 20480
    s_and_b32 s10, s10, 0xffff
    buffer_load_dwordx4 v9, s[48:51], s10 offen nt lds
    s_waitcnt vmcnt(4)
    s_add_u32 m0, s84, 24576
    s_add_u32 s10, s89, 24576
    s_and_b32 s10, s10, 0xffff
    buffer_load_dwordx4 v9, s[48:51], s10 offen nt lds
    s_waitcnt vmcnt(4)
    s_add_u32 m0, s84, 28672
    s_add_u32 s10, s89, 28672
    s_and_b32 s10, s10, 0xffff
    buffer_load_dwordx4 v9, s[48:51], s10 offen nt lds
    s_waitcnt vmcnt(4)
    v_mov_b32 v14, 7
    ds_write_b32 v12, v14
    s_add_u32 m0, s84, 32768
    s_add_u32 s10, s89, 32768
    s_and_b32 s10, s10, 0xffff
    buffer_load_dwordx4 v9, s[48:51], s10 offen nt lds
    s_waitcnt vmcnt(4)
    s_add_u32 m0, s84, 36864
    s_add_u32 s10, s89, 36864
    s_and_b32 s10, s10, 0xffff
    buffer_load_dwordx4 v9, s[48:51], s10 offen nt lds
    s_waitcnt vmcnt(4)
    s_add_u32 m0, s84, 40960
    s_add_u32 s10, s89, 40960
    s_and_b32 s10, s10, 0xffff
    buffer_load_dwordx4 v9, s[48:51], s10 offen nt lds
    s_waitcnt vmcnt(4)
    s_add_u32 m0, s84, 45056
    s_add_u32 s10, s89, 45056
    s_and_b32 s10, s10, 0xffff
    buffer_load_dwordx4 v9, s[48:51], s10 offen nt lds
    s_waitcnt vmcnt(4)
    v_mov_b32 v14, 8
    ds_write_b32 v12, v14
    s_add_u32 m0, s84, 49152
    s_add_u32 s10, s89, 49152
    s_and_b32 s10, s10, 0xffff
    buffer_load_dwordx4 v9, s[48:51], s10 offen nt lds
    s_waitcnt vmcnt(4)
    s_add_u32 m0, s84, 53248
    s_add_u32 s10, s89, 53248
    s_and_b32 s10, s10, 0xffff
    buffer_load_dwordx4 v9, s[48:51], s10 offen nt lds
    s_waitcnt vmcnt(4)
    s_add_u32 m0, s84, 57344
    s_add_u32 s10, s89, 57344
    s_and_b32 s10, s10, 0xffff
    buffer_load_dwordx4 v9, s[48:51], s10 offen nt lds
    s_waitcnt vmcnt(4)
    s_add_u32 m0, s84, 61440
    s_add_u32 s10, s89, 61440
    s_and_b32 s10, s10, 0xffff
    buffer_load_dwordx4 v9, s[48:51], s10 offen nt lds
    s_waitcnt vmcnt(4)
    v_mov_b32 v14, 9
    ds_write_b32 v12, v14
SP_5:
    ds_read_b32 v15, v5 offset:264
    s_waitcnt lgkmcnt(0)
    v_readfirstlane_b32 s10, v15
    s_cmp_ge_u32 s10, 4
    s_cbranch_scc1 SD_6
    s_sleep 1
    s_branch SP_5
SD_6:
    s_mov_b32 exec_hi, 0x00ffffff
    s_add_u32 m0, s86, 0
    s_add_u32 s10, s87, 0
    buffer_load_dwordx4 v11, s[56:59], s10 offen nt lds
    s_waitcnt vmcnt(4)
    s_add_u32 m0, s86, 928
    s_add_u32 s10, s87, 896
    buffer_load_dwordx4 v11, s[56:59], s10 offen nt lds
    s_waitcnt vmcnt(4)
    s_add_u32 m0, s86, 1856
    s_add_u32 s10, s87, 1792
    buffer_load_dwordx4 v11, s[56:59], s10 offen nt lds
    s_waitcnt vmcnt(4)
    s_add_u32 m0, s86, 2784
    s_add_u32 s10, s87, 2688
    buffer_load_dwordx4 v11, s[56:59], s10 offen nt lds
    s_waitcnt vmcnt(4)
    v_mov_b32 v14, 10
    ds_write_b32 v12, v14
    s_waitcnt vmcnt(0)
    v_mov_b32 v14, 11
    ds_write_b32 v12, v14
    s_endpgm
L_CONS:
    v_lshrrev_b32 v3, 4, v1
    v_and_b32 v4, 15, v1
    v_mov_b32 v5, 148992
    v_mov_b32 v6, 147968
    s_mov_b32 s14, 4194304
    s_mov_b32 s15, 0
    s_mov_b32 s90, 0
    s_mov_b32 s91, 0
    s_waitcnt lgkmcnt(0)
    s_add_u32 s94, s42, 3145728
    s_addc_u32 s95, s43, 0
    s_load_dwordx2 s[76:77], s[94:95], 0
    s_mov_b32 s72, s42
    s_mov_b32 s73, s43
    s_mov_b32 s74, 0x1000000
    s_mov_b32 s75, 0x00020000
    s_mov_b32 s44, s16
    s_mov_b32 s45, s17
    s_mov_b32 s46, 896
    s_mov_b32 s47, 0x00020000
    s_mov_b32 s52, s36
    s_mov_b32 s53, s37
    s_mov_b32 s54, 896
    s_mov_b32 s55, 0x00020000
    s_mov_b32 s56, s30
    s_mov_b32 s57, s31
    s_mov_b32 s58, 3584
    s_mov_b32 s59, 0x00020000
    s_mov_b32 s60, s34
    s_mov_b32 s61, s35
    s_mov_b32 s62, 896
    s_mov_b32 s63, 0x00020000
    s_mov_b32 s64, s38
    s_mov_b32 s65, s39
    s_mov_b32 s66, 896
    s_mov_b32 s67, 0x00020000
    s_mov_b32 s68, s40
    s_mov_b32 s69, s41
    s_mov_b32 s70, 256
    s_mov_b32 s71, 0x00020000
    s_cmp_lg_u32 s3, 2
    s_cbranch_scc1 L_NOG
    v_lshlrev_b32 v8, 4, v1
    buffer_load_dwordx4 v[16:19], v8, s[44:47], 0 offen
    buffer_load_dwordx4 v[20:23], v8, s[52:55], 0 offen
L_NOG:
    v_and_b32 v14, 1, v1
    v_lshl_add_u32 v14, v3, 1, v14
    v_lshlrev_b32 v14, 2, v14
    s_lshl_b32 s11, s8, 7
    s_lshl_b32 s10, s7, 5
    s_add_u32 s10, s10, s11
    buffer_load_dword v130, v14, s[56:59], s10 offen
    s_lshl_b32 s10, s5, 5
    v_add_u32 v133, s10, v14
    buffer_load_dword v131, v133, s[60:63], 0 offen
    s_cmp_lg_u32 s3, 3
    s_cbranch_scc1 L_NOZ
    v_mov_b32 v8, 0
    v_mov_b32 v9, 0
    v_mov_b32 v10, 0
    v_mov_b32 v11, 0
    v_lshlrev_b32 v12, 4, v1
    v_add_u32 v12, 147968, v12
    ds_write_b128 v12, v[8:11]
    s_mov_b32 exec_hi, 0
    ds_write_b128 v12, v[8:11] offset:1024
    s_mov_b64 exec, -1
L_NOZ:
    s_waitcnt lgkmcnt(0)
    s_add_u32 s76, s76, 0x7f4a7c15
    s_andn2_b32 s76, s76, 15
    s_xor_b32 s77, s77, 0x9e3779b9
    s_not_b32 s10, s76
    v_mov_b32 v204, s10
    v_mov_b32 v205, s10
    v_mov_b32 v206, s10
    v_mov_b32 v207, s10
    v_lshlrev_b32 v8, 4, v1
    s_lshl_b32 s13, s4, 5
    s_add_u32 s13, s13, s5
    s_lshl_b32 s10, s4, 14
    s_lshl_b32 s11, s7, 12
    s_add_u32 s10, s10, s11
    s_lshr_b32 s11, s5, 2
    s_lshl_b32 s11, s11, 9
    s_add_u32 s10, s10, s11
    s_lshl_b32 s12, s3, 7
    s_add_u32 s10, s10, s12
    s_add_u32 s10, s10, 8388608
    s_mov_b64 exec, 0xff
    buffer_load_dwordx4 v[208:211], v8, s[72:75], s10 offen sc1
    s_cmp_eq_u32 s9, 0
    s_cbranch_scc1 L_C0B
    s_lshl_b32 s10, s8, 11
    s_lshl_b32 s11, s7, 9
    s_add_u32 s10, s10, s11
    s_add_u32 s10, s10, s12
    s_add_u32 s10, s10, 8650752
    buffer_load_dwordx4 v[208:211], v8, s[72:75], s10 offen sc1
L_C0B:
    s_mov_b64 exec, -1
    s_cmp_eq_u32 s3, 1
    s_cbranch_scc1 L_C1
    s_cmp_eq_u32 s3, 2
    s_cbranch_scc1 L_C2
    s_cmp_eq_u32 s3, 3
    s_cbranch_scc1 L_C3
    s_mov_b32 exec_hi, 0
    s_lshl_b32 s10, s13, 9
    s_add_u32 s10, s10, 8781824
    buffer_load_dwordx4 v[208:211], v8, s[72:75], s10 offen sc1
    s_mov_b64 exec, -1
    s_barrier
    s_branch L_CQ
L_C1:
    s_lshl_b32 s10, s13, 12
    s_add_u32 s10, s10, 9437184
    buffer_load_dwordx4 v[208:211], v8, s[72:75], s10 offen offset:0 sc1
    buffer_load_dwordx4 v[208:211], v8, s[72:75], s10 offen offset:1024 sc1
    buffer_load_dwordx4 v[208:211], v8, s[72:75], s10 offen offset:2048 sc1
    buffer_load_dwordx4 v[208:211], v8, s[72:75], s10 offen offset:3072 sc1
    s_barrier
    s_branch L_CQ
L_C2:
    s_barrier
    s_waitcnt vmcnt(3)
    v_mov_b32 v9, 0
    v_lshlrev_b32 v10, 16, v16
    v_lshlrev_b32 v11, 16, v20
    v_and_b32 v12, 0xffff0000, v16
    v_and_b32 v13, 0xffff0000, v20
    v_mul_f32 v10, v10, v11
    v_mul_f32 v12, v12, v13
    v_cvt_pk_bf16_f32 v10, v10, v12
    v_lshlrev_b32 v11, 16, v10
    v_and_b32 v12, 0xffff0000, v10
    v_add_f32 v9, v9, v11
    v_add_f32 v9, v9, v12
    v_lshlrev_b32 v10, 16, v17
    v_lshlrev_b32 v11, 16, v21
    v_and_b32 v12, 0xffff0000, v17
    v_and_b32 v13, 0xffff0000, v21
    v_mul_f32 v10, v10, v11
    v_mul_f32 v12, v12, v13
    v_cvt_pk_bf16_f32 v10, v10, v12
    v_lshlrev_b32 v11, 16, v10
    v_and_b32 v12, 0xffff0000, v10
    v_add_f32 v9, v9, v11
    v_add_f32 v9, v9, v12
    v_lshlrev_b32 v10, 16, v18
    v_lshlrev_b32 v11, 16, v22
    v_and_b32 v12, 0xffff0000, v18
    v_and_b32 v13, 0xffff0000, v22
    v_mul_f32 v10, v10, v11
    v_mul_f32 v12, v12, v13
    v_cvt_pk_bf16_f32 v10, v10, v12
    v_lshlrev_b32 v11, 16, v10
    v_and_b32 v12, 0xffff0000, v10
    v_add_f32 v9, v9, v11
    v_add_f32 v9, v9, v12
    v_lshlrev_b32 v10, 16, v19
    v_lshlrev_b32 v11, 16, v23
    v_and_b32 v12, 0xffff0000, v19
    v_and_b32 v13, 0xffff0000, v23
    v_mul_f32 v10, v10, v11
    v_mul_f32 v12, v12, v13
    v_cvt_pk_bf16_f32 v10, v10, v12
    v_lshlrev_b32 v11, 16, v10
    v_and_b32 v12, 0xffff0000, v10
    v_add_f32 v9, v9, v11
    v_add_f32 v9, v9, v12
    s_nop 1
    v_add_f32_dpp v9, v9, v9 row_ror:1 row_mask:0xf bank_mask:0xf
    s_nop 1
    v_add_f32_dpp v9, v9, v9 row_ror:2 row_mask:0xf bank_mask:0xf
    s_nop 1
    v_add_f32_dpp v9, v9, v9 row_ror:4 row_mask:0xf bank_mask:0xf
    s_nop 1
    v_add_f32_dpp v9, v9, v9 row_ror:8 row_mask:0xf bank_mask:0xf
    v_mov_b32 v10, v9
    s_nop 1
    v_permlane16_swap_b32 v9, v10
    s_nop 0
    v_add_f32 v9, v9, v10
    v_mov_b32 v10, v9
    s_nop 1
    v_permlane32_swap_b32 v9, v10
    s_nop 0
    v_add_f32 v9, v9, v10
    v_cvt_pk_bf16_f32 v9, v9, v9
    v_lshlrev_b32 v9, 16, v9
    v_mul_f32 v9, 0xbfb8aa3b, v9
    v_exp_f32 v9, v9
    s_nop 0
    v_add_f32 v9, 1.0, v9
    v_rcp_f32 v9, v9
    s_nop 0
    v_cvt_pk_bf16_f32 v9, v9, v9
    v_lshlrev_b32 v10, 16, v9
    v_sub_f32 v11, 1.0, v10
    v_cvt_pk_bf16_f32 v11, v11, v11
    v_lshlrev_b32 v11, 16, v11
    s_mov_b64 exec, 1
    ds_write_b64 v5, v[10:11] offset:320
    s_mov_b64 exec, -1
    s_branch L_CQ
L_C3:
    s_lshl_b32 s10, s13, 12
    s_add_u32 s10, s10, 10485760
    buffer_load_dwordx4 v[208:211], v8, s[72:75], s10 offen offset:0 sc1
    buffer_load_dwordx4 v[208:211], v8, s[72:75], s10 offen offset:1024 sc1
    buffer_load_dwordx4 v[208:211], v8, s[72:75], s10 offen offset:2048 sc1
    buffer_load_dwordx4 v[208:211], v8, s[72:75], s10 offen offset:3072 sc1
    s_barrier
L_CQ:
    s_mul_i32 s10, s7, 224
    s_add_u32 s10, s10, 145408
    v_lshlrev_b32 v128, 3, v3
    v_add_u32 v128, s10, v128
    v_bfe_u32 v10, v1, 2, 2
    v_lshl_add_u32 v10, v3, 2, v10
    v_bfe_u32 v11, v10, 1, 2
    v_xor_b32 v11, s3, v11
    v_lshlrev_b32 v11, 5, v11
    v_lshl_add_u32 v11, v10, 7, v11
    v_and_b32 v10, 3, v1
    v_lshl_add_u32 v11, v10, 3, v11
    v_add_u32 v129, 131072, v11
    s_lshl_b32 s13, s4, 14
    s_lshl_b32 s11, s7, 12
    s_add_u32 s13, s13, s11
    s_lshr_b32 s11, s5, 2
    s_lshl_b32 s11, s11, 9
    s_add_u32 s13, s13, s11
    s_lshl_b32 s11, s3, 7
    s_add_u32 s13, s13, s11
    s_add_u32 s13, s13, 0
    v_lshlrev_b32 v132, 3, v1
SP_7:
    ds_read_b128 v[136:139], v6
    s_waitcnt lgkmcnt(0)
    v_min3_u32 v136, v136, v137, v138
    v_min_u32 v136, v136, v139
    s_nop 0
    v_readfirstlane_b32 s10, v136
    s_cmp_ge_u32 s10, 1
    s_cbranch_scc1 SD_8
    s_branch SP_7
SD_8:
    s_getreg_b32 s90, hwreg(HW_REG_XCC_ID, 0, 4)
    s_or_b32 s90, s90, s76
    v_mov_b32 v122, s90
    v_mov_b32 v123, s77
    ds_read2_b64 v[16:19], v128 offset0:0 offset1:4
    ds_read_b64_tr_b16 v[32:33], v129 offset:0
    ds_read_b64_tr_b16 v[34:35], v129 offset:2048
    ds_read2_b64 v[20:23], v128 offset0:8 offset1:12
    ds_read_b64_tr_b16 v[36:37], v129 offset:4096
    ds_read_b64_tr_b16 v[38:39], v129 offset:6144
    ds_read2_b64 v[24:27], v128 offset0:16 offset1:20
    ds_read_b64_tr_b16 v[40:41], v129 offset:8192
    ds_read_b64_tr_b16 v[42:43], v129 offset:10240
    ds_read_b64 v[28:29], v128 offset:192
    ds_read_b64_tr_b16 v[44:45], v129 offset:12288
    s_waitcnt lgkmcnt(8)
    v_mfma_f32_16x16x32_bf16 v[112:115], v[16:19], v[32:35], 0
    s_waitcnt lgkmcnt(5)
    v_mfma_f32_16x16x32_bf16 v[112:115], v[20:23], v[36:39], v[112:115]
    s_waitcnt lgkmcnt(2)
    v_mfma_f32_16x16x32_bf16 v[112:115], v[24:27], v[40:43], v[112:115]
    s_waitcnt lgkmcnt(0)
    v_mfma_f32_16x16x16_bf16 v[116:119], v[28:29], v[44:45], 0
    v_mov_b32 v9, 1
    s_mov_b64 exec, 1
    ds_add_u32 v5, v9 offset:276
    s_mov_b64 exec, -1
    s_nop 7
    v_add_f32 v120, v112, v116
    s_nop 1
    v_mov_b32_dpp v121, v120 quad_perm:[1,0,3,2] row_mask:0xf bank_mask:0xf
    s_waitcnt vmcnt(0)
    s_mov_b64 exec, 0x5555
    s_add_u32 s11, s13, 8388608
    buffer_store_dwordx4 v[120:123], v132, s[72:75], s11 offen
    s_mov_b64 exec, -1
    v_lshlrev_b32 v8, 4, v1
    s_lshl_b32 s11, s3, 10
    s_lshl_b32 s12, s4, 14
    s_add_u32 s12, s12, s11
    s_add_u32 s12, s12, 0
    v_add_u32 v9, 4096, v8
    v_add_u32 v10, 8192, v8
    v_add_u32 v11, 12288, v8
SP_9:
    ds_read_b128 v[136:139], v6
    s_waitcnt lgkmcnt(0)
    v_min3_u32 v136, v136, v137, v138
    v_min_u32 v136, v136, v139
    s_nop 0
    v_readfirstlane_b32 s10, v136
    s_cmp_ge_u32 s10, 2
    s_cbranch_scc1 SD_10
    s_sleep 2
    s_branch SP_9
SD_10:
L_QPOLL:
    s_sleep 1
    s_add_u32 s15, s15, 1
    s_and_b32 s11, s15, 7
    s_cmp_eq_u32 s11, 0
    s_cbranch_scc0 PF_11
    s_mov_b64 exec, 0x5555
    buffer_store_dwordx4 v[120:123], v132, s[72:75], s13 offen sc1
    s_mov_b64 exec, -1
    s_cmp_eq_u32 0, 0
PF_11:
    s_cselect_b32 s11, 0, 8388608
    s_add_u32 s11, s11, s12
    buffer_load_dwordx4 v[16:19], v8, s[72:75], s11 offen sc1
    buffer_load_dwordx4 v[20:23], v9, s[72:75], s11 offen sc1
    buffer_load_dwordx4 v[24:27], v10, s[72:75], s11 offen sc1
    buffer_load_dwordx4 v[28:31], v11, s[72:75], s11 offen sc1
    s_waitcnt vmcnt(0)
    v_xor_b32 v32, s90, v18
    v_and_b32 v18, -16, v18
    v_xor_b32 v33, s90, v22
    v_and_b32 v22, -16, v22
    v_xor_b32 v34, s90, v26
    v_and_b32 v26, -16, v26
    v_xor_b32 v35, s90, v30
    v_and_b32 v30, -16, v30
    v_cmp_eq_u64 vcc, s[76:77], v[18:19]
    v_cmp_eq_u64 s[86:87], s[76:77], v[22:23]
    s_and_b64 vcc, vcc, s[86:87]
    v_cmp_eq_u64 s[86:87], s[76:77], v[26:27]
    s_and_b64 vcc, vcc, s[86:87]
    v_cmp_eq_u64 s[86:87], s[76:77], v[30:31]
    s_and_b64 vcc, vcc, s[86:87]
    s_sub_u32 s14, s14, 1
    s_cbranch_scc1 L_QPOLL_DONE
    s_cmp_eq_u64 vcc, exec
    s_cbranch_scc0 L_QPOLL
L_QPOLL_DONE:
    s_mov_b64 exec, 0x5555
    buffer_store_dwordx4 v[120:123], v132, s[72:75], s13 offen sc1
    s_mov_b64 exec, -1
    v_or3_b32 v32, v32, v33, v34
    v_or_b32 v32, v32, v35
    v_cmp_ne_u32 vcc, 0, v32
    s_mov_b32 s90, 0
    s_cmp_lg_u64 vcc, 0
    s_cselect_b32 s10, 1, 0
    v_mov_b32 v33, s10
    s_mov_b64 exec, 1
    ds_add_u32 v5, v33 offset:272
    s_mov_b64 exec, -1
    v_mov_b32 v122, s76
    v_add_f32 v16, v16, v20
    v_add_f32 v17, v17, v21
    v_add_f32 v24, v24, v28
    v_add_f32 v25, v25, v29
    v_add_f32 v16, v16, v24
    v_add_f32 v17, v17, v25
    v_cvt_pk_bf16_f32 v16, v16, v17
    s_lshl_b32 s11, s3, 8
    s_add_u32 s11, s11, 146432
    v_lshlrev_b32 v9, 2, v1
    v_add_u32 v9, s11, v9
    v_mov_b32 v10, 1
    ds_write_b32 v9, v16
    s_waitcnt lgkmcnt(0)
    s_mov_b64 exec, 1
    ds_add_u32 v5, v10 offset:256
    s_mov_b64 exec, -1
    v_and_b32 v8, 1, v1
    v_lshlrev_b32 v8, 9, v8
    v_lshl_add_u32 v8, v3, 4, v8
    v_add_u32 v8, 146432, v8
    v_and_b32 v9, 3, v4
    v_xor_b32 v9, v3, v9
    v_and_b32 v10, 12, v4
    v_or_b32 v9, v9, v10
    v_lshlrev_b32 v9, 4, v9
    v_lshl_add_u32 v9, v4, 10, v9
    s_lshl_b32 s10, s3, 14
    v_add_u32 v9, s10, v9
    v_xor_b32 v10, 64, v9
    v_xor_b32 v11, 128, v9
    v_xor_b32 v12, 192, v9
    s_add_u32 s13, s3, 2
SP_12:
    ds_read_b128 v[136:139], v6
    s_waitcnt lgkmcnt(0)
    v_min3_u32 v136, v136, v137, v138
    v_min_u32 v136, v136, v139
    s_nop 0
    v_readfirstlane_b32 s10, v136
    s_cmp_ge_u32 s10, s13
    s_cbranch_scc1 SD_13
    s_sleep 1
    s_branch SP_12
SD_13:
    ds_read_b128 v[140:143], v9 offset:0
    ds_read_b128 v[144:147], v10 offset:0
    ds_read_b128 v[148:151], v11 offset:0
    ds_read_b128 v[152:155], v12 offset:0
    ds_read_b128 v[156:159], v9 offset:256
    ds_read_b128 v[160:163], v10 offset:256
    ds_read_b128 v[164:167], v11 offset:256
    ds_read_b128 v[168:171], v12 offset:256
    ds_read_b128 v[172:175], v9 offset:512
    ds_read_b128 v[176:179], v10 offset:512
    ds_read_b128 v[180:183], v11 offset:512
    ds_read_b128 v[184:187], v12 offset:512
    ds_read_b128 v[188:191], v9 offset:768
    ds_read_b128 v[192:195], v10 offset:768
    ds_read_b128 v[196:199], v11 offset:768
    ds_read_b128 v[200:203], v12 offset:768
SP_14:
    ds_read_b32 v13, v5 offset:256
    s_waitcnt lgkmcnt(0)
    v_readfirstlane_b32 s10, v13
    s_cmp_ge_u32 s10, 4
    s_cbranch_scc1 SD_15
    s_branch SP_14
SD_15:
    ds_read_b32 v14, v5 offset:272
    ds_read_b128 v[40:43], v8 offset:0
    ds_read_b128 v[44:47], v8 offset:64
    ds_read_b128 v[48:51], v8 offset:128
    ds_read_b128 v[52:55], v8 offset:192
    ds_read_b128 v[56:59], v8 offset:256
    ds_read_b128 v[60:63], v8 offset:320
    ds_read_b128 v[64:67], v8 offset:384
    ds_read_b128 v[68:71], v8 offset:448
    s_waitcnt lgkmcnt(7)
    v_mfma_f32_16x16x32_bf16 v[112:115], v[40:43], v[140:143], 0
    v_mfma_f32_16x16x32_bf16 v[116:119], v[40:43], v[172:175], 0
    s_waitcnt lgkmcnt(6)
    v_readfirstlane_b32 s101, v14
    s_cmp_eq_u32 s101, 0
    s_cselect_b32 s101, 8388608, 0
    v_mfma_f32_16x16x32_bf16 v[112:115], v[44:47], v[144:147], v[112:115]
    v_mfma_f32_16x16x32_bf16 v[116:119], v[44:47], v[176:179], v[116:119]
    s_waitcnt lgkmcnt(5)
    v_mfma_f32_16x16x32_bf16 v[112:115], v[48:51], v[148:151], v[112:115]
    v_mfma_f32_16x16x32_bf16 v[116:119], v[48:51], v[180:183], v[116:119]
    s_waitcnt lgkmcnt(4)
    v_mfma_f32_16x16x32_bf16 v[112:115], v[52:55], v[152:155], v[112:115]
    v_mfma_f32_16x16x32_bf16 v[116:119], v[52:55], v[184:187], v[116:119]
    s_waitcnt lgkmcnt(3)
    v_mfma_f32_16x16x32_bf16 v[112:115], v[56:59], v[156:159], v[112:115]
    v_mfma_f32_16x16x32_bf16 v[116:119], v[56:59], v[188:191], v[116:119]
    s_waitcnt lgkmcnt(2)
    v_mfma_f32_16x16x32_bf16 v[112:115], v[60:63], v[160:163], v[112:115]
    v_mfma_f32_16x16x32_bf16 v[116:119], v[60:63], v[192:195], v[116:119]
    s_waitcnt lgkmcnt(1)
    v_mfma_f32_16x16x32_bf16 v[112:115], v[64:67], v[164:167], v[112:115]
    v_mfma_f32_16x16x32_bf16 v[116:119], v[64:67], v[196:199], v[116:119]
    s_waitcnt lgkmcnt(0)
    v_mfma_f32_16x16x32_bf16 v[112:115], v[68:71], v[168:171], v[112:115]
    v_mfma_f32_16x16x32_bf16 v[116:119], v[68:71], v[200:203], v[116:119]
    s_mov_b32 s12, 0x3db8aa3b
    s_lshl_b32 s11, s3, 3
    v_mov_b32 v8, s11
    v_add_u32 v8, 148992, v8
    s_nop 4
    v_cvt_pk_bf16_f32 v120, v112, v116
    v_cvt_pk_bf16_f32 v121, v113, v117
    v_lshlrev_b32 v16, 16, v120
    v_and_b32 v17, 0xffff0000, v120
    v_lshlrev_b32 v18, 16, v121
    v_and_b32 v19, 0xffff0000, v121
    v_max_f32 v20, v16, v17
    v_max_f32 v21, v18, v19
    s_nop 0
    v_max_f32_dpp v20, v20, v20 row_ror:1 row_mask:0xf bank_mask:0xf
    v_max_f32_dpp v21, v21, v21 row_ror:1 row_mask:0xf bank_mask:0xf
    s_nop 0
    v_max_f32_dpp v20, v20, v20 row_ror:2 row_mask:0xf bank_mask:0xf
    v_max_f32_dpp v21, v21, v21 row_ror:2 row_mask:0xf bank_mask:0xf
    s_nop 0
    v_max_f32_dpp v20, v20, v20 row_ror:4 row_mask:0xf bank_mask:0xf
    v_max_f32_dpp v21, v21, v21 row_ror:4 row_mask:0xf bank_mask:0xf
    s_nop 0
    v_max_f32_dpp v20, v20, v20 row_ror:8 row_mask:0xf bank_mask:0xf
    v_max_f32_dpp v21, v21, v21 row_ror:8 row_mask:0xf bank_mask:0xf
    v_mov_b32 v9, 1
    s_mov_b64 exec, 1
    ds_write_b64 v8, v[20:21]
    s_waitcnt lgkmcnt(0)
    ds_add_u32 v5, v9 offset:264
    s_mov_b64 exec, -1
SP_16:
    ds_read_b32 v13, v5 offset:264
    s_waitcnt lgkmcnt(0)
    v_readfirstlane_b32 s10, v13
    s_cmp_ge_u32 s10, 4
    s_cbranch_scc1 SD_17
    s_branch SP_16
SD_17:
    ds_read_b128 v[24:27], v5 offset:0
    ds_read_b128 v[28:31], v5 offset:16
    s_waitcnt lgkmcnt(0)
    v_max_f32 v20, v24, v26
    v_max_f32 v21, v25, v27
    v_max3_f32 v20, v20, v28, v30
    v_max3_f32 v21, v21, v29, v31
    v_sub_f32 v16, v16, v20
    v_sub_f32 v17, v17, v20
    v_sub_f32 v18, v18, v21
    v_sub_f32 v19, v19, v21
    v_mul_f32 v16, s12, v16
    v_mul_f32 v17, s12, v17
    v_mul_f32 v18, s12, v18
    v_mul_f32 v19, s12, v19
    v_exp_f32 v16, v16
    v_exp_f32 v17, v17
    v_exp_f32 v18, v18
    v_exp_f32 v19, v19
    s_nop 0
    v_cvt_pk_bf16_f32 v24, v16, v17
    v_cvt_pk_bf16_f32 v25, v18, v19
    v_add_f32 v22, v16, v17
    v_add_f32 v23, v18, v19
    s_lshl_b32 s11, s3, 6
    s_add_u32 s11, s11, 147456
    v_lshlrev_b32 v8, 2, v4
    v_add_u32 v8, s11, v8
    s_mov_b64 exec, 0xffff
    ds_write_b32 v8, v24
    ds_write_b32 v8, v25 offset:256
    s_mov_b64 exec, -1
    s_nop 0
    v_add_f32_dpp v22, v22, v22 row_ror:1 row_mask:0xf bank_mask:0xf
    v_add_f32_dpp v23, v23, v23 row_ror:1 row_mask:0xf bank_mask:0xf
    s_nop 0
    v_add_f32_dpp v22, v22, v22 row_ror:2 row_mask:0xf bank_mask:0xf
    v_add_f32_dpp v23, v23, v23 row_ror:2 row_mask:0xf bank_mask:0xf
    s_nop 0
    v_add_f32_dpp v22, v22, v22 row_ror:4 row_mask:0xf bank_mask:0xf
    v_add_f32_dpp v23, v23, v23 row_ror:4 row_mask:0xf bank_mask:0xf
    s_nop 0
    v_add_f32_dpp v22, v22, v22 row_ror:8 row_mask:0xf bank_mask:0xf
    v_add_f32_dpp v23, v23, v23 row_ror:8 row_mask:0xf bank_mask:0xf
    s_mov_b64 exec, 1
    ds_add_f32 v5, v22 offset:32
    ds_add_f32 v5, v23 offset:36
    s_waitcnt lgkmcnt(0)
    ds_add_u32 v5, v9 offset:268
    s_mov_b64 exec, -1
    v_and_b32 v10, 1, v1
    v_lshlrev_b32 v10, 8, v10
    v_lshl_add_u32 v10, v3, 3, v10
    v_add_u32 v10, 147456, v10
    v_bfe_u32 v11, v1, 2, 2
    v_lshl_add_u32 v12, v3, 2, v11
    v_and_b32 v13, 7, v12
    s_lshl_b32 s11, s3, 2
    v_xor_b32 v13, s11, v13
    v_lshlrev_b32 v13, 5, v13
    v_lshl_add_u32 v13, v12, 9, v13
    v_and_b32 v14, 3, v1
    v_lshl_add_u32 v13, v14, 3, v13
    v_add_u32 v32, 65536, v13
    v_xor_b32 v33, 32, v32
    v_xor_b32 v34, 64, v32
    v_xor_b32 v35, 96, v32
    v_mul_u32_u24 v134, 928, v12
    v_lshl_add_u32 v134, v14, 3, v134
    s_mul_i32 s10, s3, 224
    v_add_u32 v134, s10, v134
SP_18:
    ds_read_b32 v13, v5 offset:268
    s_waitcnt lgkmcnt(0)
    v_readfirstlane_b32 s10, v13
    s_cmp_ge_u32 s10, 4
    s_cbranch_scc1 SD_19
    s_branch SP_18
SD_19:
    ds_read2_b64 v[36:39], v10 offset0:0 offset1:4
    ds_read2_b64 v[40:43], v10 offset0:8 offset1:12
    ds_read2_b64 v[44:47], v10 offset0:16 offset1:20
    ds_read2_b64 v[48:51], v10 offset0:24 offset1:28
    ds_read_b64 v[220:221], v5 offset:320
    s_cmp_lg_u32 s3, 0
    s_cbranch_scc1 NOSTAT_20
    ds_read_b64 v[22:23], v5 offset:32
    v_cmp_eq_u32 vcc, 1, v3
    s_lshl_b32 s10, s4, 14
    s_lshl_b32 s11, s5, 4
    s_add_u32 s10, s10, s11
    s_add_u32 s10, s10, 393216
    v_lshlrev_b32 v8, 9, v1
    s_waitcnt lgkmcnt(0)
    v_cndmask_b32 v120, v20, v21, vcc
    v_cndmask_b32 v121, v22, v23, vcc
    s_mov_b32 exec_hi, 0
    s_add_u32 s11, s10, s101
    s_cmp_eq_u32 s101, 0
    s_cbranch_scc1 PS_21
    buffer_store_dwordx4 v[120:123], v8, s[72:75], s11 offen
    s_branch PD_22
PS_21:
    buffer_store_dwordx4 v[120:123], v8, s[72:75], s11 offen sc1
PD_22:
    s_mov_b64 exec, -1
NOSTAT_20:
    v_cmp_eq_u32 s[78:79], 2, v3
    v_cmp_eq_u32 s[80:81], 3, v3
    v_cmp_eq_u32 s[82:83], 1, v3
    v_and_b32 v8, 1, v1
    v_cmp_eq_u32 s[84:85], 1, v8
    v_lshl_add_u32 v135, v8, 4, v3
    v_lshlrev_b32 v135, 12, v135
    v_lshrrev_b32 v10, 1, v4
    v_lshl_add_u32 v135, v10, 4, v135
    s_lshl_b32 s100, s4, 5
    s_lshl_b32 s11, s3, 2
    s_add_u32 s100, s100, s11
    s_lshl_b32 s100, s100, 12
    s_lshl_b32 s11, s5, 7
    s_add_u32 s100, s100, s11
    s_add_u32 s100, s100, 1048576
    s_cmp_eq_u32 s9, 0
    s_cbranch_scc1 L_NOFFN1
    s_lshl_b32 s12, s8, 11
    s_lshl_b32 s11, s7, 9
    s_add_u32 s12, s12, s11
    s_lshl_b32 s11, s3, 7
    s_add_u32 s12, s12, s11
    s_add_u32 s12, s12, 262144
SP_23:
    ds_read_b128 v[136:139], v6
    s_waitcnt lgkmcnt(0)
    v_min3_u32 v136, v136, v137, v138
    v_min_u32 v136, v136, v139
    s_nop 0
    v_readfirstlane_b32 s10, v136
    s_cmp_ge_u32 s10, 6
    s_cbranch_scc1 SD_24
    s_sleep 1
    s_branch SP_23
SD_24:
    ds_read2_b64 v[140:143], v128 offset0:0 offset1:4
    ds_read_b64_tr_b16 v[156:157], v129 offset:0
    ds_read_b64_tr_b16 v[158:159], v129 offset:2048
    ds_read2_b64 v[144:147], v128 offset0:8 offset1:12
    ds_read_b64_tr_b16 v[160:161], v129 offset:4096
    ds_read_b64_tr_b16 v[162:163], v129 offset:6144
    ds_read2_b64 v[148:151], v128 offset0:16 offset1:20
    ds_read_b64_tr_b16 v[164:165], v129 offset:8192
    ds_read_b64_tr_b16 v[166:167], v129 offset:10240
    ds_read_b64 v[152:153], v128 offset:192
    ds_read_b64_tr_b16 v[168:169], v129 offset:12288
    s_waitcnt lgkmcnt(8)
    v_mfma_f32_16x16x32_bf16 v[112:115], v[140:143], v[156:159], 0
    s_waitcnt lgkmcnt(5)
    v_mfma_f32_16x16x32_bf16 v[112:115], v[144:147], v[160:163], v[112:115]
    s_waitcnt lgkmcnt(2)
    v_mfma_f32_16x16x32_bf16 v[112:115], v[148:151], v[164:167], v[112:115]
    s_waitcnt lgkmcnt(0)
    v_mfma_f32_16x16x16_bf16 v[116:119], v[152:153], v[168:169], 0
    s_nop 7
    v_add_f32 v120, v112, v116
    s_nop 1
    v_mov_b32_dpp v121, v120 quad_perm:[1,0,3,2] row_mask:0xf bank_mask:0xf
    s_mov_b64 exec, 0x5555
    s_add_u32 s11, s12, s101
    s_cmp_eq_u32 s101, 0
    s_cbranch_scc1 PS_25
    buffer_store_dwordx4 v[120:123], v132, s[72:75], s11 offen
    s_branch PD_26
PS_25:
    buffer_store_dwordx4 v[120:123], v132, s[72:75], s11 offen sc1
PD_26:
    s_mov_b64 exec, -1
L_NOFFN1:
    s_lshl_b32 s98, s4, 5
    s_add_u32 s98, s98, s5
    s_lshl_b32 s92, s98, 12
    s_lshl_b32 s98, s98, 9
    s_add_u32 s98, s98, 393216
    s_add_u32 s98, s98, s101
    s_add_u32 s92, s92, s101
    v_bfe_u32 v14, v1, 1, 3
    v_lshlrev_b32 v192, 4, v14
    v_and_b32 v15, 1, v1
    v_lshl_add_u32 v15, v3, 1, v15
    v_lshlrev_b32 v15, 4, v15
    v_lshl_add_u32 v197, v14, 7, v15
    s_lshl_b32 s99, s8, 11
    s_lshl_b32 s11, s7, 7
    s_add_u32 s99, s99, s11
    s_add_u32 s99, s99, 262144
    s_add_u32 s99, s99, s101
    v_and_b32 v14, 3, v14
    v_lshl_add_u32 v193, v14, 9, v15
    v_and_b32 v8, 1, v1
    v_lshl_add_u32 v222, v8, 2, v3
    v_lshlrev_b32 v222, 12, v222
    v_lshrrev_b32 v10, 1, v4
    v_lshl_add_u32 v222, v10, 4, v222
    s_mul_i32 s93, s3, 7
    s_lshl_b32 s11, s4, 5
    s_add_u32 s93, s93, s11
    s_lshl_b32 s93, s93, 12
    s_lshl_b32 s11, s5, 7
    s_add_u32 s93, s93, s11
    s_add_u32 s93, s93, 2097152
    v_mov_b32 v126, s76
    v_mov_b32 v127, s77
    v_mov_b32 v202, s76
    v_mov_b32 v203, s77
    s_mov_b32 s94, 0
    s_xor_b32 s95, s9, 1
    v_mov_b32 v96, 0
    v_mov_b32 v100, 0
    v_mov_b32 v104, 0
    v_mov_b32 v108, 0
    v_mov_b32 v112, 0
    v_mov_b32 v116, 0
    v_mov_b32 v120, 0
SP_27:
    ds_read_b128 v[136:139], v6
    s_waitcnt lgkmcnt(0)
    v_min3_u32 v136, v136, v137, v138
    v_min_u32 v136, v136, v139
    s_nop 0
    v_readfirstlane_b32 s10, v136
    s_cmp_ge_u32 s10, 7
    s_cbranch_scc1 SD_28
    s_sleep 1
    s_branch SP_27
SD_28:
    ds_read_b64_tr_b16 v[52:53], v32 offset:0
    ds_read_b64_tr_b16 v[54:55], v32 offset:8192
    ds_read_b64_tr_b16 v[56:57], v33 offset:0
    ds_read_b64_tr_b16 v[58:59], v33 offset:8192
    ds_read_b64_tr_b16 v[60:61], v34 offset:0
    ds_read_b64_tr_b16 v[62:63], v34 offset:8192
    ds_read_b64_tr_b16 v[64:65], v35 offset:0
    ds_read_b64_tr_b16 v[66:67], v35 offset:8192
    s_waitcnt lgkmcnt(6)
    v_mfma_f32_16x16x32_bf16 v[68:71], v[36:39], v[52:55], 0
    s_waitcnt lgkmcnt(4)
    v_mfma_f32_16x16x32_bf16 v[72:75], v[36:39], v[56:59], 0
    s_waitcnt lgkmcnt(2)
    v_mfma_f32_16x16x32_bf16 v[76:79], v[36:39], v[60:63], 0
    s_waitcnt lgkmcnt(0)
    v_mfma_f32_16x16x32_bf16 v[80:83], v[36:39], v[64:67], 0
SP_29:
    ds_read_b128 v[136:139], v6
    s_waitcnt lgkmcnt(0)
    v_min3_u32 v136, v136, v137, v138
    v_min_u32 v136, v136, v139
    s_nop 0
    v_readfirstlane_b32 s10, v136
    s_cmp_ge_u32 s10, 8
    s_cbranch_scc1 SD_30
    s_sleep 1
    s_branch SP_29
SD_30:
    ds_read_b64_tr_b16 v[52:53], v32 offset:16384
    ds_read_b64_tr_b16 v[54:55], v32 offset:24576
    ds_read_b64_tr_b16 v[56:57], v33 offset:16384
    ds_read_b64_tr_b16 v[58:59], v33 offset:24576
    ds_read_b64_tr_b16 v[60:61], v34 offset:16384
    ds_read_b64_tr_b16 v[62:63], v34 offset:24576
    ds_read_b64_tr_b16 v[64:65], v35 offset:16384
    ds_read_b64_tr_b16 v[66:67], v35 offset:24576
    s_waitcnt lgkmcnt(6)
    v_mfma_f32_16x16x32_bf16 v[68:71], v[40:43], v[52:55], v[68:71]
    s_waitcnt lgkmcnt(4)
    v_mfma_f32_16x16x32_bf16 v[72:75], v[40:43], v[56:59], v[72:75]
    s_waitcnt lgkmcnt(2)
    v_mfma_f32_16x16x32_bf16 v[76:79], v[40:43], v[60:63], v[76:79]
    s_waitcnt lgkmcnt(0)
    v_mfma_f32_16x16x32_bf16 v[80:83], v[40:43], v[64:67], v[80:83]
    buffer_load_dwordx4 v[172:175], v192, s[72:75], s98 offen offset:0 sc1
    buffer_load_dwordx4 v[176:179], v192, s[72:75], s98 offen offset:128 sc1
    buffer_load_dwordx4 v[180:183], v192, s[72:75], s98 offen offset:256 sc1
    buffer_load_dwordx4 v[184:187], v192, s[72:75], s98 offen offset:384 sc1
    buffer_load_dwordx4 v[188:191], v193, s[72:75], s99 offen sc1
SP_31:
    ds_read_b128 v[136:139], v6
    s_waitcnt lgkmcnt(0)
    v_min3_u32 v136, v136, v137, v138
    v_min_u32 v136, v136, v139
    s_nop 0
    v_readfirstlane_b32 s10, v136
    s_cmp_ge_u32 s10, 9
    s_cbranch_scc1 SD_32
    s_sleep 1
    s_branch SP_31
SD_32:
    ds_read_b64_tr_b16 v[52:53], v32 offset:32768
    ds_read_b64_tr_b16 v[54:55], v32 offset:40960
    ds_read_b64_tr_b16 v[56:57], v33 offset:32768
    ds_read_b64_tr_b16 v[58:59], v33 offset:40960
    ds_read_b64_tr_b16 v[60:61], v34 offset:32768
    ds_read_b64_tr_b16 v[62:63], v34 offset:40960
    ds_read_b64_tr_b16 v[64:65], v35 offset:32768
    ds_read_b64_tr_b16 v[66:67], v35 offset:40960
    s_waitcnt lgkmcnt(6)
    v_mfma_f32_16x16x32_bf16 v[68:71], v[44:47], v[52:55], v[68:71]
    s_waitcnt lgkmcnt(4)
    v_mfma_f32_16x16x32_bf16 v[72:75], v[44:47], v[56:59], v[72:75]
    s_waitcnt lgkmcnt(2)
    v_mfma_f32_16x16x32_bf16 v[76:79], v[44:47], v[60:63], v[76:79]
    s_waitcnt lgkmcnt(0)
    v_mfma_f32_16x16x32_bf16 v[80:83], v[44:47], v[64:67], v[80:83]
    s_waitcnt vmcnt(0)
    v_cmp_eq_u64 vcc, s[76:77], v[174:175]
    v_cmp_eq_u64 s[86:87], s[76:77], v[178:179]
    s_and_b64 vcc, vcc, s[86:87]
    v_cmp_eq_u64 s[86:87], s[76:77], v[182:183]
    s_and_b64 vcc, vcc, s[86:87]
    v_cmp_eq_u64 s[86:87], s[76:77], v[186:187]
    s_and_b64 vcc, vcc, s[86:87]
    s_cmp_eq_u64 vcc, exec
    s_cbranch_scc0 E1_33
    v_max_f32 v194, v172, v176
    v_max3_f32 v194, v194, v180, v184
    s_nop 1
    v_max_f32_dpp v194, v194, v194 row_ror:2 row_mask:0xf bank_mask:0xf
    s_nop 1
    v_max_f32_dpp v194, v194, v194 row_ror:4 row_mask:0xf bank_mask:0xf
    s_nop 1
    v_max_f32_dpp v194, v194, v194 row_ror:8 row_mask:0xf bank_mask:0xf
    s_mov_b32 s12, 0x3db8aa3b
    v_sub_f32 v172, v172, v194
    v_sub_f32 v176, v176, v194
    v_sub_f32 v180, v180, v194
    v_sub_f32 v184, v184, v194
    v_mul_f32 v172, s12, v172
    v_mul_f32 v176, s12, v176
    v_mul_f32 v180, s12, v180
    v_mul_f32 v184, s12, v184
    v_exp_f32 v172, v172
    v_exp_f32 v176, v176
    v_exp_f32 v180, v180
    v_exp_f32 v184, v184
    s_nop 0
    v_mul_f32 v196, v172, v173
    v_fmac_f32 v196, v176, v177
    v_fmac_f32 v196, v180, v181
    v_fmac_f32 v196, v184, v185
    s_nop 1
    v_add_f32_dpp v196, v196, v196 row_ror:2 row_mask:0xf bank_mask:0xf
    s_nop 1
    v_add_f32_dpp v196, v196, v196 row_ror:4 row_mask:0xf bank_mask:0xf
    s_nop 1
    v_add_f32_dpp v196, v196, v196 row_ror:8 row_mask:0xf bank_mask:0xf
    v_rcp_f32 v196, v196
    s_nop 0
    v_mul_f32 v172, v172, v196
    v_mul_f32 v176, v176, v196
    v_mul_f32 v180, v180, v196
    v_mul_f32 v184, v184, v196
    s_mov_b32 s90, 1
E1_33:
    s_cmp_eq_u32 s9, 0
    s_cbranch_scc1 E2_34
    v_cmp_eq_u64 vcc, s[76:77], v[190:191]
    s_cmp_eq_u64 vcc, exec
    s_cbranch_scc0 E2_34
    s_nop 0
    v_add_f32_dpp v188, v188, v188 row_ror:2 row_mask:0xf bank_mask:0xf
    v_add_f32_dpp v189, v189, v189 row_ror:2 row_mask:0xf bank_mask:0xf
    s_nop 0
    v_add_f32_dpp v188, v188, v188 row_ror:4 row_mask:0xf bank_mask:0xf
    v_add_f32_dpp v189, v189, v189 row_ror:4 row_mask:0xf bank_mask:0xf
    v_cvt_pk_bf16_f32 v188, v188, v189
    v_lshlrev_b32 v190, 16, v188
    v_and_b32 v191, 0xffff0000, v188
    v_lshlrev_b32 v194, 16, v130
    v_and_b32 v195, 0xffff0000, v130
    v_add_f32 v190, v190, v194
    v_add_f32 v191, v191, v195
    v_cvt_pk_bf16_f32 v188, v190, v191
    v_lshlrev_b32 v190, 16, v188
    v_and_b32 v191, 0xffff0000, v188
    v_max_f32 v190, 0, v190
    v_max_f32 v191, 0, v191
    v_mul_f32 v190, v190, v190
    v_mul_f32 v191, v191, v191
    v_cvt_pk_bf16_f32 v188, v190, v191
    s_nop 1
    v_mov_b32_dpp v198, v188 quad_perm:[0,0,2,2] row_mask:0xf bank_mask:0xf
    v_mov_b32_dpp v199, v188 quad_perm:[1,1,3,3] row_mask:0xf bank_mask:0xf
    s_mov_b32 s91, 1
E2_34:
SP_35:
    ds_read_b128 v[136:139], v6
    s_waitcnt lgkmcnt(0)
    v_min3_u32 v136, v136, v137, v138
    v_min_u32 v136, v136, v139
    s_nop 0
    v_readfirstlane_b32 s10, v136
    s_cmp_ge_u32 s10, 10
    s_cbranch_scc1 SD_36
    s_branch SP_35
SD_36:
    ds_read_b64_tr_b16 v[52:53], v32 offset:49152
    ds_read_b64_tr_b16 v[54:55], v32 offset:57344
    ds_read_b64_tr_b16 v[56:57], v33 offset:49152
    ds_read_b64_tr_b16 v[58:59], v33 offset:57344
    ds_read_b64_tr_b16 v[60:61], v34 offset:49152
    ds_read_b64_tr_b16 v[62:63], v34 offset:57344
    ds_read_b64_tr_b16 v[64:65], v35 offset:49152
    ds_read_b64_tr_b16 v[66:67], v35 offset:57344
    s_waitcnt lgkmcnt(6)
    v_mfma_f32_16x16x32_bf16 v[68:71], v[48:51], v[52:55], v[68:71]
    s_waitcnt lgkmcnt(4)
    v_mfma_f32_16x16x32_bf16 v[72:75], v[48:51], v[56:59], v[72:75]
    s_waitcnt lgkmcnt(2)
    v_mfma_f32_16x16x32_bf16 v[76:79], v[48:51], v[60:63], v[76:79]
    s_waitcnt lgkmcnt(0)
    v_mfma_f32_16x16x32_bf16 v[80:83], v[48:51], v[64:67], v[80:83]
    s_nop 5
    v_cndmask_b32 v16, v68, v72, s[82:83]
    v_cndmask_b32 v17, v69, v73, s[82:83]
    v_cndmask_b32 v16, v16, v76, s[78:79]
    v_cndmask_b32 v17, v17, v77, s[78:79]
    v_cndmask_b32 v16, v16, v80, s[80:81]
    v_cndmask_b32 v17, v17, v81, s[80:81]
    s_nop 0
    v_mov_b32_dpp v18, v16 quad_perm:[1,0,3,2] row_mask:0xf bank_mask:0xf
    v_mov_b32_dpp v19, v17 quad_perm:[1,0,3,2] row_mask:0xf bank_mask:0xf
    s_nop 0
    v_cndmask_b32 v200, v16, v19, s[84:85]
    v_cndmask_b32 v201, v18, v17, s[84:85]
    s_add_u32 s11, s100, s101
    s_cmp_eq_u32 s101, 0
    s_cbranch_scc1 PS_37
    buffer_store_dwordx4 v[200:203], v135, s[72:75], s11 offen
    s_branch PD_38
PS_37:
    buffer_store_dwordx4 v[200:203], v135, s[72:75], s11 offen sc1
PD_38:
    s_cmp_lg_u32 s90, 0
    s_cbranch_scc1 L_TOK
L_TPOLL:
    buffer_load_dwordx4 v[172:175], v192, s[72:75], s98 offen offset:0 sc1
    buffer_load_dwordx4 v[176:179], v192, s[72:75], s98 offen offset:128 sc1
    buffer_load_dwordx4 v[180:183], v192, s[72:75], s98 offen offset:256 sc1
    buffer_load_dwordx4 v[184:187], v192, s[72:75], s98 offen offset:384 sc1
    s_waitcnt vmcnt(0)
    v_cmp_eq_u64 vcc, s[76:77], v[174:175]
    v_cmp_eq_u64 s[86:87], s[76:77], v[178:179]
    s_and_b64 vcc, vcc, s[86:87]
    v_cmp_eq_u64 s[86:87], s[76:77], v[182:183]
    s_and_b64 vcc, vcc, s[86:87]
    v_cmp_eq_u64 s[86:87], s[76:77], v[186:187]
    s_and_b64 vcc, vcc, s[86:87]
    s_sub_u32 s14, s14, 1
    s_cbranch_scc1 L_TPOLL_DONE
    s_cmp_eq_u64 vcc, exec
    s_cbranch_scc0 L_TPOLL
L_TPOLL_DONE:
    v_max_f32 v194, v172, v176
    v_max3_f32 v194, v194, v180, v184
    s_nop 1
    v_max_f32_dpp v194, v194, v194 row_ror:2 row_mask:0xf bank_mask:0xf
    s_nop 1
    v_max_f32_dpp v194, v194, v194 row_ror:4 row_mask:0xf bank_mask:0xf
    s_nop 1
    v_max_f32_dpp v194, v194, v194 row_ror:8 row_mask:0xf bank_mask:0xf
    s_mov_b32 s12, 0x3db8aa3b
    v_sub_f32 v172, v172, v194
    v_sub_f32 v176, v176, v194
    v_sub_f32 v180, v180, v194
    v_sub_f32 v184, v184, v194
    v_mul_f32 v172, s12, v172
    v_mul_f32 v176, s12, v176
    v_mul_f32 v180, s12, v180
    v_mul_f32 v184, s12, v184
    v_exp_f32 v172, v172
    v_exp_f32 v176, v176
    v_exp_f32 v180, v180
    v_exp_f32 v184, v184
    s_nop 0
    v_mul_f32 v196, v172, v173
    v_fmac_f32 v196, v176, v177
    v_fmac_f32 v196, v180, v181
    v_fmac_f32 v196, v184, v185
    s_nop 1
    v_add_f32_dpp v196, v196, v196 row_ror:2 row_mask:0xf bank_mask:0xf
    s_nop 1
    v_add_f32_dpp v196, v196, v196 row_ror:4 row_mask:0xf bank_mask:0xf
    s_nop 1
    v_add_f32_dpp v196, v196, v196 row_ror:8 row_mask:0xf bank_mask:0xf
    v_rcp_f32 v196, v196
    s_nop 0
    v_mul_f32 v172, v172, v196
    v_mul_f32 v176, v176, v196
    v_mul_f32 v180, v180, v196
    v_mul_f32 v184, v184, v196
    s_mov_b32 s90, 1
L_TOK:
    s_cmp_lg_u32 s95, 0
    s_cbranch_scc1 L_FDONE0
    s_cmp_lg_u32 s91, 0
    s_cbranch_scc1 L_HOK
L_HPOLL:
    buffer_load_dwordx4 v[188:191], v193, s[72:75], s99 offen sc1
    s_waitcnt vmcnt(0)
    v_cmp_eq_u64 vcc, s[76:77], v[190:191]
    s_sub_u32 s14, s14, 1
    s_cbranch_scc1 L_HPOLL_DONE
    s_cmp_eq_u64 vcc, exec
    s_cbranch_scc0 L_HPOLL
L_HPOLL_DONE:
    s_nop 0
    v_add_f32_dpp v188, v188, v188 row_ror:2 row_mask:0xf bank_mask:0xf
    v_add_f32_dpp v189, v189, v189 row_ror:2 row_mask:0xf bank_mask:0xf
    s_nop 0
    v_add_f32_dpp v188, v188, v188 row_ror:4 row_mask:0xf bank_mask:0xf
    v_add_f32_dpp v189, v189, v189 row_ror:4 row_mask:0xf bank_mask:0xf
    v_cvt_pk_bf16_f32 v188, v188, v189
    v_lshlrev_b32 v190, 16, v188
    v_and_b32 v191, 0xffff0000, v188
    v_lshlrev_b32 v194, 16, v130
    v_and_b32 v195, 0xffff0000, v130
    v_add_f32 v190, v190, v194
    v_add_f32 v191, v191, v195
    v_cvt_pk_bf16_f32 v188, v190, v191
    v_lshlrev_b32 v190, 16, v188
    v_and_b32 v191, 0xffff0000, v188
    v_max_f32 v190, 0, v190
    v_max_f32 v191, 0, v191
    v_mul_f32 v190, v190, v190
    v_mul_f32 v191, v191, v191
    v_cvt_pk_bf16_f32 v188, v190, v191
    s_nop 1
    v_mov_b32_dpp v198, v188 quad_perm:[0,0,2,2] row_mask:0xf bank_mask:0xf
    v_mov_b32_dpp v199, v188 quad_perm:[1,1,3,3] row_mask:0xf bank_mask:0xf
    s_mov_b32 s91, 1
L_HOK:
L_FDONE0:
    s_add_u32 s12, s92, 1048576
L_OPOLL:
    buffer_load_dwordx4 v[48:51], v197, s[72:75], s12 offen offset:0 sc1
    buffer_load_dwordx4 v[52:55], v197, s[72:75], s12 offen offset:1024 sc1
    buffer_load_dwordx4 v[56:59], v197, s[72:75], s12 offen offset:2048 sc1
    buffer_load_dwordx4 v[60:63], v197, s[72:75], s12 offen offset:3072 sc1
    s_and_b32 s10, s94, s95
    s_cbranch_scc1 L_OCHK
    ds_read_b128 v[136:139], v6
    s_waitcnt lgkmcnt(0)
    v_min3_u32 v136, v136, v137, v138
    v_min_u32 v136, v136, v139
    s_nop 0
    v_readfirstlane_b32 s13, v136
    s_cmp_lg_u32 s94, 0
    s_cbranch_scc1 L_OC2
    s_cmp_ge_u32 s13, 11
    s_cbranch_scc0 L_OC2
    ds_read_b64_tr_b16 v[140:141], v134 offset:0
    ds_read_b64_tr_b16 v[142:143], v134 offset:32
    ds_read_b64_tr_b16 v[144:145], v134 offset:64
    ds_read_b64_tr_b16 v[146:147], v134 offset:96
    ds_read_b64_tr_b16 v[148:149], v134 offset:128
    ds_read_b64_tr_b16 v[150:151], v134 offset:160
    ds_read_b64_tr_b16 v[152:153], v134 offset:192
    s_mov_b32 s94, 1
L_OC2:
    s_cmp_lg_u32 s95, 0
    s_cbranch_scc1 L_OCHK
    s_cmp_ge_u32 s13, 12
    s_cbranch_scc0 L_OCHK
    ds_read_b64_tr_b16 v[156:157], v134 offset:14848
    ds_read_b64_tr_b16 v[158:159], v134 offset:14880
    ds_read_b64_tr_b16 v[160:161], v134 offset:14912
    ds_read_b64_tr_b16 v[162:163], v134 offset:14944
    ds_read_b64_tr_b16 v[164:165], v134 offset:14976
    ds_read_b64_tr_b16 v[166:167], v134 offset:15008
    ds_read_b64_tr_b16 v[168:169], v134 offset:15040
    s_waitcnt lgkmcnt(6)
    v_mfma_f32_16x16x16_bf16 v[96:99], v[198:199], v[156:157], 0
    s_waitcnt lgkmcnt(5)
    v_mfma_f32_16x16x16_bf16 v[100:103], v[198:199], v[158:159], 0
    s_waitcnt lgkmcnt(4)
    v_mfma_f32_16x16x16_bf16 v[104:107], v[198:199], v[160:161], 0
    s_waitcnt lgkmcnt(3)
    v_mfma_f32_16x16x16_bf16 v[108:111], v[198:199], v[162:163], 0
    s_waitcnt lgkmcnt(2)
    v_mfma_f32_16x16x16_bf16 v[112:115], v[198:199], v[164:165], 0
    s_waitcnt lgkmcnt(1)
    v_mfma_f32_16x16x16_bf16 v[116:119], v[198:199], v[166:167], 0
    s_waitcnt lgkmcnt(0)
    v_mfma_f32_16x16x16_bf16 v[120:123], v[198:199], v[168:169], 0
    s_nop 2
    v_mul_f32 v96, v221, v96
    v_mul_f32 v100, v221, v100
    v_mul_f32 v104, v221, v104
    v_mul_f32 v108, v221, v108
    v_mul_f32 v112, v221, v112
    v_mul_f32 v116, v221, v116
    s_nop 1
    v_mul_f32 v120, v221, v120
    s_mov_b32 s95, 1
L_OCHK:
    s_waitcnt vmcnt(0)
    v_cmp_eq_u64 vcc, s[76:77], v[50:51]
    v_cmp_eq_u64 s[86:87], s[76:77], v[54:55]
    s_and_b64 vcc, vcc, s[86:87]
    v_cmp_eq_u64 s[86:87], s[76:77], v[58:59]
    s_and_b64 vcc, vcc, s[86:87]
    v_cmp_eq_u64 s[86:87], s[76:77], v[62:63]
    s_and_b64 vcc, vcc, s[86:87]
    s_sub_u32 s14, s14, 1
    s_cbranch_scc1 L_OPOLL_DONE
    s_cmp_eq_u64 vcc, exec
    s_cbranch_scc0 L_OPOLL
L_OPOLL_DONE:
    v_mul_f32 v40, v172, v48
    v_mul_f32 v41, v172, v49
    v_fmac_f32 v40, v176, v52
    v_fmac_f32 v41, v176, v53
    v_fmac_f32 v40, v180, v56
    v_fmac_f32 v41, v180, v57
    v_fmac_f32 v40, v184, v60
    v_fmac_f32 v41, v184, v61
    s_nop 0
    v_add_f32_dpp v40, v40, v40 row_ror:2 row_mask:0xf bank_mask:0xf
    v_add_f32_dpp v41, v41, v41 row_ror:2 row_mask:0xf bank_mask:0xf
    s_nop 0
    v_add_f32_dpp v40, v40, v40 row_ror:4 row_mask:0xf bank_mask:0xf
    v_add_f32_dpp v41, v41, v41 row_ror:4 row_mask:0xf bank_mask:0xf
    s_nop 0
    v_add_f32_dpp v40, v40, v40 row_ror:8 row_mask:0xf bank_mask:0xf
    v_add_f32_dpp v41, v41, v41 row_ror:8 row_mask:0xf bank_mask:0xf
    v_cvt_pk_bf16_f32 v40, v40, v41
    s_nop 1
    v_mov_b32_dpp v46, v40 quad_perm:[0,0,2,2] row_mask:0xf bank_mask:0xf
    v_mov_b32_dpp v47, v40 quad_perm:[1,1,3,3] row_mask:0xf bank_mask:0xf
    s_cmp_lg_u32 s94, 0
    s_cbranch_scc1 L_WD1
SP_39:
    ds_read_b128 v[136:139], v6
    s_waitcnt lgkmcnt(0)
    v_min3_u32 v136, v136, v137, v138
    v_min_u32 v136, v136, v139
    s_nop 0
    v_readfirstlane_b32 s10, v136
    s_cmp_ge_u32 s10, 11
    s_cbranch_scc1 SD_40
    s_branch SP_39
SD_40:
    ds_read_b64_tr_b16 v[140:141], v134 offset:0
    ds_read_b64_tr_b16 v[142:143], v134 offset:32
    ds_read_b64_tr_b16 v[144:145], v134 offset:64
    ds_read_b64_tr_b16 v[146:147], v134 offset:96
    ds_read_b64_tr_b16 v[148:149], v134 offset:128
    ds_read_b64_tr_b16 v[150:151], v134 offset:160
    ds_read_b64_tr_b16 v[152:153], v134 offset:192
    s_mov_b32 s94, 1
L_WD1:
    s_cmp_lg_u32 s95, 0
    s_cbranch_scc1 L_WDONE
SP_41:
    ds_read_b128 v[136:139], v6
    s_waitcnt lgkmcnt(0)
    v_min3_u32 v136, v136, v137, v138
    v_min_u32 v136, v136, v139
    s_nop 0
    v_readfirstlane_b32 s10, v136
    s_cmp_ge_u32 s10, 12
    s_cbranch_scc1 SD_42
    s_branch SP_41
SD_42:
    ds_read_b64_tr_b16 v[156:157], v134 offset:14848
    ds_read_b64_tr_b16 v[158:159], v134 offset:14880
    ds_read_b64_tr_b16 v[160:161], v134 offset:14912
    ds_read_b64_tr_b16 v[162:163], v134 offset:14944
    ds_read_b64_tr_b16 v[164:165], v134 offset:14976
    ds_read_b64_tr_b16 v[166:167], v134 offset:15008
    ds_read_b64_tr_b16 v[168:169], v134 offset:15040
    s_waitcnt lgkmcnt(6)
    v_mfma_f32_16x16x16_bf16 v[96:99], v[198:199], v[156:157], 0
    s_waitcnt lgkmcnt(5)
    v_mfma_f32_16x16x16_bf16 v[100:103], v[198:199], v[158:159], 0
    s_waitcnt lgkmcnt(4)
    v_mfma_f32_16x16x16_bf16 v[104:107], v[198:199], v[160:161], 0
    s_waitcnt lgkmcnt(3)
    v_mfma_f32_16x16x16_bf16 v[108:111], v[198:199], v[162:163], 0
    s_waitcnt lgkmcnt(2)
    v_mfma_f32_16x16x16_bf16 v[112:115], v[198:199], v[164:165], 0
    s_waitcnt lgkmcnt(1)
    v_mfma_f32_16x16x16_bf16 v[116:119], v[198:199], v[166:167], 0
    s_waitcnt lgkmcnt(0)
    v_mfma_f32_16x16x16_bf16 v[120:123], v[198:199], v[168:169], 0
    s_nop 2
    v_mul_f32 v96, v221, v96
    v_mul_f32 v100, v221, v100
    v_mul_f32 v104, v221, v104
    v_mul_f32 v108, v221, v108
    v_mul_f32 v112, v221, v112
    v_mul_f32 v116, v221, v116
    s_nop 1
    v_mul_f32 v120, v221, v120
    s_mov_b32 s95, 1
L_WDONE:
    s_waitcnt lgkmcnt(0)
    v_mfma_f32_16x16x16_bf16 v[68:71], v[46:47], v[140:141], 0
    v_mfma_f32_16x16x16_bf16 v[72:75], v[46:47], v[142:143], 0
    v_mfma_f32_16x16x16_bf16 v[76:79], v[46:47], v[144:145], 0
    v_mfma_f32_16x16x16_bf16 v[80:83], v[46:47], v[146:147], 0
    v_mfma_f32_16x16x16_bf16 v[84:87], v[46:47], v[148:149], 0
    v_mfma_f32_16x16x16_bf16 v[88:91], v[46:47], v[150:151], 0
    v_mfma_f32_16x16x16_bf16 v[92:95], v[46:47], v[152:153], 0
    s_nop 2
    v_fmac_f32 v96, v220, v68
    v_fmac_f32 v100, v220, v72
    v_fmac_f32 v104, v220, v76
    v_fmac_f32 v108, v220, v80
    v_fmac_f32 v112, v220, v84
    v_fmac_f32 v116, v220, v88
    s_nop 0
    v_fmac_f32 v120, v220, v92
    v_cndmask_b32 v16, v96, v100, s[82:83]
    v_cndmask_b32 v17, v112, v116, s[82:83]
    v_cndmask_b32 v16, v16, v104, s[78:79]
    v_cndmask_b32 v17, v17, v120, s[78:79]
    v_cndmask_b32 v16, v16, v108, s[80:81]
    s_nop 1
    v_mov_b32_dpp v18, v16 quad_perm:[1,0,3,2] row_mask:0xf bank_mask:0xf
    v_mov_b32_dpp v19, v17 quad_perm:[1,0,3,2] row_mask:0xf bank_mask:0xf
    s_nop 0
    v_cndmask_b32 v124, v16, v19, s[84:85]
    v_cndmask_b32 v125, v18, v17, s[84:85]
    s_mov_b32 exec_hi, 0x5555ffff
    s_add_u32 s11, s93, s101
    s_cmp_eq_u32 s101, 0
    s_cbranch_scc1 PS_43
    buffer_store_dwordx4 v[124:127], v222, s[72:75], s11 offen
    s_branch PD_44
PS_43:
    buffer_store_dwordx4 v[124:127], v222, s[72:75], s11 offen sc1
PD_44:
    s_mov_b64 exec, -1
    s_cmp_eq_u32 s3, 0
    s_cselect_b32 s10, s5, 99
    s_cmp_lt_u32 s10, 28
    s_cbranch_scc0 L_CEND
    s_add_u32 s13, s92, 2097152
    s_lshl_b32 s12, s5, 10
    s_add_u32 s12, s12, 655360
    s_lshl_b32 s11, s4, 7
    s_add_u32 s11, s11, s12
L_RPOLL:
    buffer_load_dwordx4 v[48:51], v197, s[72:75], s13 offen offset:0 sc1
    buffer_load_dwordx4 v[52:55], v197, s[72:75], s13 offen offset:1024 sc1
    buffer_load_dwordx4 v[56:59], v197, s[72:75], s13 offen offset:2048 sc1
    buffer_load_dwordx4 v[60:63], v197, s[72:75], s13 offen offset:3072 sc1
    s_waitcnt vmcnt(0)
    v_cmp_eq_u64 vcc, s[76:77], v[50:51]
    v_cmp_eq_u64 s[86:87], s[76:77], v[54:55]
    s_and_b64 vcc, vcc, s[86:87]
    v_cmp_eq_u64 s[86:87], s[76:77], v[58:59]
    s_and_b64 vcc, vcc, s[86:87]
    v_cmp_eq_u64 s[86:87], s[76:77], v[62:63]
    s_and_b64 vcc, vcc, s[86:87]
    s_sub_u32 s14, s14, 1
    s_cbranch_scc1 L_RPOLL_DONE
    s_cmp_eq_u64 vcc, exec
    s_cbranch_scc0 L_RPOLL
L_RPOLL_DONE:
    v_add_f32 v48, v48, v52
    v_add_f32 v49, v49, v53
    v_add_f32 v56, v56, v60
    v_add_f32 v57, v57, v61
    v_add_f32 v48, v48, v56
    v_add_f32 v49, v49, v57
    s_nop 0
    v_add_f32_dpp v48, v48, v48 row_ror:2 row_mask:0xf bank_mask:0xf
    v_add_f32_dpp v49, v49, v49 row_ror:2 row_mask:0xf bank_mask:0xf
    s_nop 0
    v_add_f32_dpp v48, v48, v48 row_ror:4 row_mask:0xf bank_mask:0xf
    v_add_f32_dpp v49, v49, v49 row_ror:4 row_mask:0xf bank_mask:0xf
    s_nop 0
    v_add_f32_dpp v48, v48, v48 row_ror:8 row_mask:0xf bank_mask:0xf
    v_add_f32_dpp v49, v49, v49 row_ror:8 row_mask:0xf bank_mask:0xf
    v_mov_b32 v50, s76
    v_mov_b32 v51, s77
    s_mov_b32 exec_lo, 0x00030003
    s_mov_b32 exec_hi, 0x00030003
    buffer_store_dwordx4 v[48:51], v197, s[72:75], s11 offen sc1
    s_mov_b64 exec, -1
    s_and_b32 s10, s5, 7
    s_cmp_eq_u32 s10, s4
    s_cbranch_scc0 L_CEND
    v_lshlrev_b32 v22, 16, v131
    v_and_b32 v23, 0xffff0000, v131
L_FPOLL:
    buffer_load_dwordx4 v[16:19], v197, s[72:75], s12 offen sc1
    s_waitcnt vmcnt(0)
    v_cmp_eq_u64 vcc, s[76:77], v[18:19]
    s_sub_u32 s14, s14, 1
    s_cbranch_scc1 L_FPOLL_DONE
    s_cmp_eq_u64 vcc, exec
    s_cbranch_scc0 L_FPOLL
L_FPOLL_DONE:
    s_nop 0
    v_add_f32_dpp v16, v16, v16 row_ror:2 row_mask:0xf bank_mask:0xf
    v_add_f32_dpp v17, v17, v17 row_ror:2 row_mask:0xf bank_mask:0xf
    s_nop 0
    v_add_f32_dpp v16, v16, v16 row_ror:4 row_mask:0xf bank_mask:0xf
    v_add_f32_dpp v17, v17, v17 row_ror:4 row_mask:0xf bank_mask:0xf
    s_nop 0
    v_add_f32_dpp v16, v16, v16 row_ror:8 row_mask:0xf bank_mask:0xf
    v_add_f32_dpp v17, v17, v17 row_ror:8 row_mask:0xf bank_mask:0xf
    v_fmac_f32 v16, v221, v22
    v_fmac_f32 v17, v221, v23
    v_cvt_pk_bf16_f32 v16, v16, v17
    s_mov_b32 exec_lo, 0x00030003
    s_mov_b32 exec_hi, 0x00030003
    buffer_store_dword v16, v133, s[64:67], 0 offen
    s_cmp_lg_u32 s2, 0
    s_cbranch_scc1 L_NOEP
    v_mov_b32 v8, 3145728
    v_mov_b32 v12, s76
    v_mov_b32 v13, s77
    s_mov_b64 exec, 1
    buffer_store_dwordx2 v[12:13], v8, s[72:75], 0 offen sc1
L_NOEP:
L_CEND:
L_END:
    s_endpgm
L_CODE_END:
.section .rodata,"a"
.p2align 6
.amdhsa_kernel gated_mix__sliding_block_cached__dense_activation_squared_relu__decode_kernel
  .amdhsa_next_free_vgpr 256
  .amdhsa_next_free_sgpr 102
  .amdhsa_accum_offset 256
  .amdhsa_group_segment_fixed_size 0
  .amdhsa_kernarg_size 112
  .amdhsa_user_sgpr_count 2
  .amdhsa_user_sgpr_kernarg_segment_ptr 1
  .amdhsa_system_sgpr_workgroup_id_x 1
.end_amdhsa_kernel
```
